```python
import torch

def _softmax(x, axis=-1):
    return torch.softmax(x, dim=axis)
def _gelu(x):
    return torch.nn.functional.gelu(x, approximate="tanh")
def _silu(x):
    return torch.nn.functional.silu(x)
def _sigmoid(x):
    return torch.sigmoid(x)
def _layernorm(x, axis=-1, eps=1e-5):
    m = x.mean(dim=axis, keepdim=True)
    v = x.var(dim=axis, keepdim=True, unbiased=False)
    return (x - m) / torch.sqrt(v + eps)
def _scatter_add(tgt, idx, src, axis=0):
    return tgt.clone().index_add_(axis, idx, src)
def _segment_sum(src, seg, n):
    out = torch.zeros((n,) + src.shape[1:], dtype=src.dtype)
    return out.index_add_(0, seg, src)
def _pad(x, pw):
    flat = tuple(v for pair in reversed(pw) for v in pair)
    return torch.nn.functional.pad(x, flat)

kernel_name = 'concat_heads__ssm_conv_s4__grouped_kv_mqa__prompt'

def setup_inputs():

    _w = (lambda a: (lambda t: t.to(torch.bfloat16) if t.is_floating_point() else t)(torch.as_tensor(a)))
    def _A_setup():
        B, L, D, N = 1, 2048, 512, 128
        A_re = -(lambda _x: torch.exp(torch.as_tensor(_x)))((lambda *s: torch.randn(*s, dtype=torch.bfloat16) * 3.2)(D, N))
        A_im = torch.pi * (lambda *s: torch.randn(*s, dtype=torch.bfloat16) * 0.05)(D, N)
        B_re = (lambda *s: torch.randn(*s, dtype=torch.bfloat16) * 0.1)(D, N)
        B_im = (lambda *s: torch.randn(*s, dtype=torch.bfloat16) * 0.1)(D, N)
        C_re = (lambda *s: torch.randn(*s, dtype=torch.bfloat16) * 0.1)(D, N)
        C_im = (lambda *s: torch.randn(*s, dtype=torch.bfloat16) * 0.1)(D, N)
        log_dt = (lambda *s: torch.randn(*s, dtype=torch.bfloat16) * 0.05)(D) * 0.5 - 4.0
        Dskip = (lambda *s: torch.randn(*s, dtype=torch.bfloat16) * 0.05)(D)
        return {
            "u": _w((lambda *s: torch.randn(*s, dtype=torch.bfloat16) * 0.05)(B, L, D)),
            "A_re": _w(A_re),
            "A_im": _w(A_im),
            "B_re": _w(B_re),
            "B_im": _w(B_im),
            "C_re": _w(C_re),
            "C_im": _w(C_im),
            "log_dt": _w(log_dt),
            "Dskip": _w(Dskip),
        }
    _A_in = _A_setup()

    def _B_setup():
        B, S, D, H = 1, 2048, 512, 32
        Dh = D // H
        return {
            "x": _w((lambda *s: torch.randn(*s, dtype=torch.bfloat16) * 0.05)(B, S, D)),
            "wq": _w((lambda *s: torch.randn(*s, dtype=torch.bfloat16) * 0.8)(D, H * Dh)),
            "wk": _w((lambda *s: torch.randn(*s, dtype=torch.bfloat16) * 0.8)(D, Dh)),
            "wv": _w((lambda *s: torch.randn(*s, dtype=torch.bfloat16) * 0.05)(D, Dh)),
            "wo": _w((lambda *s: torch.randn(*s, dtype=torch.bfloat16) * 0.05)(H * Dh, D)),
        }
    _B_in = _B_setup()

    return {
        "A_u": _A_in["u"],
        "A_A_re": _A_in["A_re"],
        "A_A_im": _A_in["A_im"],
        "A_B_re": _A_in["B_re"],
        "A_B_im": _A_in["B_im"],
        "A_C_re": _A_in["C_re"],
        "A_C_im": _A_in["C_im"],
        "A_log_dt": _A_in["log_dt"],
        "A_Dskip": _A_in["Dskip"],
        "B_x": _B_in["x"],
        "B_wq": _B_in["wq"],
        "B_wk": _B_in["wk"],
        "B_wv": _B_in["wv"],
        "B_wo": _B_in["wo"],
    }

def reference(A_u, A_A_re, A_A_im, A_B_re, A_B_im, A_C_re, A_C_im, A_log_dt, A_Dskip, B_x, B_wq, B_wk, B_wv, B_wo):
    def _A_ref(u, A_re, A_im, B_re, B_im, C_re, C_im, log_dt, Dskip):
        Bsz, L, D = u.shape
        dt = torch.exp(log_dt)[:, None]
        A = A_re + 1j * A_im
        Bc = B_re + 1j * B_im
        Cc = C_re + 1j * C_im
        logdA = dt * A
        dB = dt * Bc
        l = (lambda x, dt: x.to(dt))(torch.arange(L), A_re.dtype)
        P = torch.exp(logdA[:, :, None] * l[None, None, :])
        K = torch.einsum("dn,dnl,dn->dl", Cc, P, dB).real
        L2 = 2 * L
        Kp = _pad(K, ((0, 0), (0, L)))
        up = (lambda x, *d: x.permute(*d))(u, 0, 2, 1)
        up = _pad(up, ((0, 0), (0, 0), (0, L)))
        Kf = (lambda x, axes=(-2,-1): torch.fft.rfft2(x.float(), dim=axes))(Kp[:, None, :], axes=(-2, -1))
        Uf = (lambda x, axes=(-2,-1): torch.fft.rfft2(x.float(), dim=axes))(up[:, :, None, :], axes=(-2, -1))
        Yf = Uf * Kf[None, :, :, :]
        y = (lambda x, s, axes=(-2,-1): torch.fft.irfft2(x, s=s, dim=axes).to(torch.bfloat16))(Yf, (1, L2), axes=(-2, -1))[:, :, 0, :L]
        y = (lambda x, *d: x.permute(*d))(y, 0, 2, 1) + u * Dskip[None, None, :]
        return y

    def _B_ref(x, wq, wk, wv, wo):
        B, S, D = x.shape
        H = 32
        Dh = D // H
        q = (lambda x, *d: x.permute(*d))((x @ wq).reshape(B, S, H, Dh), 0, 2, 1, 3)
        k = x @ wk
        v = x @ wv
        scores = torch.einsum("bhqd,bkd->bhqk", q, k) * (Dh ** -0.5)
        p = _softmax(scores, axis=-1)
        o = torch.einsum("bhqk,bkd->bhqd", p, v)
        return (lambda x, *d: x.permute(*d))(o, 0, 2, 1, 3).reshape(B, S, H * Dh) @ wo

    a = _A_ref(A_u, A_A_re, A_A_im, A_B_re, A_B_im, A_C_re, A_C_im, A_log_dt, A_Dskip)
    b = _B_ref(B_x, B_wq, B_wk, B_wv, B_wo)
    return torch.concatenate([a, b], axis=-1)
```

```asm
; @launch grid=(256,1,1) block=(512,1,1) lds=163840
.amdgcn_target "amdgcn-amd-amdhsa--gfx950"
.text
.globl concat_heads__ssm_conv_s4__grouped_kv_mqa__prompt_kernel
.p2align 8
.type concat_heads__ssm_conv_s4__grouped_kv_mqa__prompt_kernel,@function
concat_heads__ssm_conv_s4__grouped_kv_mqa__prompt_kernel:
    s_cmp_ge_u32 s2, 256
    s_cbranch_scc1 L_end
    s_load_dwordx16 s[16:31], s[0:1], 0
    s_load_dwordx16 s[32:47], s[0:1], 64
    s_load_dwordx2 s[48:49], s[0:1], 128
    s_getpc_b64 s[80:81]
L_pc_ref:
    s_bfe_u32 s9, s2, 0x30003
    v_lshl_add_u32 v2, v0, 3, s9
    v_lshlrev_b32 v2, 7, v2
    v_cmp_gt_u32 vcc, (L_code_end - L_pc_ref), v2
    s_and_saveexec_b64 s[82:83], vcc
    s_cbranch_execz L_nopf_1
    global_load_dword v248, v2, s[80:81]
L_nopf_1:
    s_mov_b64 exec, -1
    s_and_b32 s9, s2, 7
    s_lshl_b32 s9, s9, 5
    s_lshr_b32 s10, s2, 3
    s_add_u32 s4, s9, s10
    s_mov_b32 s3, s4
    s_mov_b32 s50, 0
    s_mov_b32 s91, 0
    v_lshrrev_b32 v2, 6, v0
    v_and_b32 v1, 63, v0
    v_readfirstlane_b32 s5, v2
    v_lshlrev_b32 v15, 4, v1
    v_and_b32 v4, 7, v0
    v_lshrrev_b32 v3, 3, v1
    s_and_b32 s11, s5, 3
    s_lshl_b32 s11, s11, 14
    v_lshrrev_b32 v5, 1, v3
    v_xor_b32 v5, v5, v4
    v_lshlrev_b32 v5, 4, v5
    v_lshl_add_u32 v5, v3, 10, v5
    v_add_u32 v58, s11, v5
    v_and_b32 v5, 2, v3
    v_lshlrev_b32 v5, 1, v5
    v_xor_b32 v5, v5, v4
    v_lshlrev_b32 v5, 4, v5
    v_lshl_add_u32 v5, v3, 10, v5
    v_add_u32 v60, s11, v5
    v_xor_b32 v59, 0x2040, v58
    v_xor_b32 v61, 0x2020, v60
    s_lshr_b32 s100, s11, 3
    v_and_b32 v2, 255, v0
    v_lshlrev_b32 v2, 1, v2
    s_lshl_b32 s9, s4, 9
    v_add_u32 v9, s9, v2
    s_lshl_b32 s92, s5, 10
    s_mov_b32 s54, 0x700000
    s_mov_b32 s55, 0x00020000
    s_mov_b32 s58, 0x400000
    s_mov_b32 s59, 0x00020000
    s_mov_b32 s62, 0x200000
    s_mov_b32 s63, 0x00020000
    s_mov_b32 s66, 0x80000
    s_mov_b32 s67, 0x00020000
    s_mov_b32 s70, 0x200000
    s_mov_b32 s71, 0x00020000
    s_mov_b32 s74, 0x80000
    s_mov_b32 s75, 0x00020000
    s_mov_b32 s78, 0x4000
    s_mov_b32 s79, 0x00020000
    s_lshl_b32 s9, s4, 2
    s_waitcnt lgkmcnt(0)
    s_load_dword s84, s[30:31], s9
    s_load_dword s85, s[32:33], s9
    s_mov_b64 s[68:69], s[16:17]
    s_mov_b64 s[60:61], s[34:35]
    s_mov_b64 s[64:65], s[36:37]
    s_mov_b64 s[52:53], s[48:49]
    s_mov_b64 s[56:57], s[44:45]
    s_mov_b64 s[72:73], s[42:43]
L_phase1:
    global_load_ushort v192, v9, s[18:19]
    global_load_ushort v193, v9, s[20:21]
    v_mov_b32 v2, 4884480
    buffer_load_dword v11, v2, s[52:55], 0 offen sc1
    s_lshr_b32 s6, s3, 3
    s_and_b32 s7, s3, 7
    s_lshl_b32 s9, s6, 1
    s_add_u32 s8, s9, s7
    s_and_b32 s8, s8, 7
    s_lshl_b32 s98, s6, 16
    s_lshl_b32 s99, s7, 7
    s_cmp_lt_u32 s5, 4
    s_cbranch_scc1 L_r1e_3
    global_load_ushort v194, v9, s[22:23]
    global_load_ushort v195, v9, s[24:25]
    global_load_ushort v196, v9, s[26:27]
    global_load_ushort v197, v9, s[28:29]
    s_and_b32 s9, s3, 31
    s_lshl_b32 s9, s9, 16
    s_lshr_b32 s10, s3, 5
    s_lshl_b32 s10, s10, 7
    s_add_u32 m0, s100, 151552
    s_add_u32 s9, s9, s10
    buffer_load_dwordx4 v60, s[68:71], s9 offen lds
    s_add_u32 m0, s100, 152576
    s_nop 0
    buffer_load_dwordx4 v61, s[68:71], s9 offen lds
L_r1e_3:
    s_bitcmp1_b32 s7, 0
    s_cselect_b32 s76, s40, s38
    s_cselect_b32 s77, s41, s39
    v_lshrrev_b32 v2, 4, v1
    v_bfe_u32 v3, v1, 2, 2
    v_and_b32 v4, 3, v1
    v_lshrrev_b32 v7, 5, v1
    v_and_b32 v8, 15, v1
    s_lshr_b32 s90, s5, 2
    v_and_b32 v6, 1, v1
    v_and_b32 v5, 2, v3
    v_or_b32 v5, v6, v5
    v_xor_b32 v5, v5, v7
    v_lshlrev_b32 v5, 5, v5
    v_lshl_add_u32 v5, v3, 7, v5
    v_lshl_add_u32 v5, v6, 10, v5
    v_bfe_u32 v6, v1, 1, 1
    v_lshl_add_u32 v5, v6, 3, v5
    v_and_b32 v6, 16, v1
    s_add_u32 s9, s100, 151552
    v_add3_u32 v27, s9, v5, v6
    v_lshrrev_b32 v5, 3, v1
    v_lshlrev_b32 v5, 14, v5
    v_and_b32 v6, 7, v1
    v_lshl_add_u32 v28, v6, 4, v5
    v_and_b32 v5, 127, v0
    s_lshr_b32 s9, s5, 1
    s_xor_b32 s10, s9, 2
    s_mul_i32 s10, s10, 17408
    s_add_u32 s10, s10, 65536
    v_lshl_add_u32 v26, v5, 2, s10
    v_mul_u32_u24 v5, 544, v8
    v_lshl_add_u32 v5, v2, 4, v5
    s_mul_i32 s10, s9, 8704
    s_add_u32 s10, s10, 65536
    v_add_u32 v24, s10, v5
    s_lshl_b32 s10, s90, 1
    s_and_b32 s11, s5, 1
    s_add_u32 s10, s10, s11
    s_mul_i32 s10, s10, 8704
    s_add_u32 s10, s10, 100352
    v_add_u32 v25, s10, v5
    v_lshlrev_b32 v5, 4, v8
    s_mul_i32 s9, s90, 4160
    s_add_u32 s9, s9, 151552
    s_lshl_b32 s11, s11, 8
    s_sub_u32 s10, s9, s11
    v_sub_u32 v30, s10, v5
    v_cmp_le_u32 vcc, 32, v1
    v_and_b32 v6, 1, v2
    v_mov_b32 v34, 0x1000100
    s_bitcmp1_b32 s5, 1
    s_cbranch_scc1 L_rt1_5
    v_lshlrev_b32 v5, 9, v7
    v_lshl_add_u32 v5, v6, 3, v5
    v_sub_u32 v30, v30, v5
    v_mov_b32 v5, 0x5040706
    v_mov_b32 v6, 0x3020504
    v_cndmask_b32 v31, v5, v6, vcc
    v_mov_b32 v5, 0x1000302
    v_cndmask_b32 v32, v5, v34, vcc
    s_branch L_c0e_6
L_rt1_5:
    v_lshlrev_b32 v6, 9, v6
    v_add_u32 v6, 1024, v6
    v_lshlrev_b32 v6, v7, v6
    v_sub_u32 v30, v30, v6
    v_mov_b32 v5, 0x5040504
    v_mov_b32 v6, 0x3020302
    v_cndmask_b32 v31, v5, v6, vcc
    v_and_b32 v5, 1, v1
    v_mul_u32_u24 v5, 0x202, v5
    v_lshlrev_b32 v5, 16, v5
    v_add_u32 v5, 0x1000302, v5
    v_cndmask_b32 v32, v6, v5, vcc
    v_mov_b32 v5, 0x1000302
    v_cndmask_b32 v33, v5, v34, vcc
L_c0e_6:
    s_cmp_ge_u32 s5, 4
    s_cbranch_scc1 L_pk_7
    v_lshl_add_u32 v5, v7, 3, v3
    v_and_b32 v6, 2, v3
    v_or_b32 v6, v6, v7
    v_and_b32 v3, 1, v2
    s_and_b32 s9, s5, 1
    s_lshl_b32 s9, s9, 1
    v_or_b32 v3, s9, v3
    v_xor_b32 v6, v6, v3
    v_lshlrev_b32 v6, 5, v6
    v_lshl_add_u32 v6, v5, 7, v6
    v_and_b32 v5, 1, v1
    v_lshl_add_u32 v6, v5, 4, v6
    v_bfe_u32 v5, v1, 1, 1
    v_lshl_add_u32 v6, v5, 3, v6
    v_add_u32 v18, 8192, v6
    v_and_b32 v5, 31, v1
    v_bfe_u32 v6, v1, 1, 3
    v_xor_b32 v6, v6, v7
    v_lshlrev_b32 v6, 4, v6
    v_lshl_add_u32 v6, v5, 7, v6
    s_lshr_b32 s9, s5, 1
    s_lshl_b32 s9, s9, 12
    v_add_u32 v19, s9, v6
    v_xor_b32 v20, 32, v19
    v_xor_b32 v21, 64, v19
    v_xor_b32 v22, 0x60, v19
    s_branch L_pj_8
L_pk_7:
    v_lshl_add_u32 v5, v2, 3, v3
    v_lshlrev_b32 v6, 3, v4
    v_lshl_add_u32 v18, v5, 5, v6
    v_add_u32 v18, 135168, v18
    v_lshrrev_b32 v5, 1, v8
    v_xor_b32 v5, v5, v2
    v_lshlrev_b32 v5, 4, v5
    v_lshl_add_u32 v5, v8, 7, v5
    s_lshr_b32 s9, s7, 1
    s_lshl_b32 s9, s9, 11
    v_add_u32 v19, s9, v5
    v_xor_b32 v20, 64, v19
L_pj_8:
    s_cmp_ge_u32 s5, 4
    s_cbranch_scc1 L_p0_9
    s_add_u32 s12, s8, 0
    s_and_b32 s12, s12, 7
    s_lshl_b32 s12, s12, 7
    s_add_u32 m0, s100, 0
    s_add_u32 s12, s12, s98
    buffer_load_dwordx4 v58, s[60:63], s12 offen lds
    s_add_u32 m0, s100, 1024
    s_nop 0
    buffer_load_dwordx4 v59, s[60:63], s12 offen lds
L_p0_9:
    v_and_b32 v5, 255, v0
    s_mul_i32 s9, s90, 4160
    s_add_u32 s9, s9, 151552
    v_lshl_add_u32 v42, v5, 4, s9
    s_mul_i32 s9, s90, 16640
    s_add_u32 s9, s9, 32256
    v_lshl_add_u32 v36, v5, 4, s9
    v_and_b32 v4, 3, v1
    v_lshrrev_b32 v7, 5, v1
    v_lshlrev_b32 v249, 4, v0
    v_cmp_le_u32 vcc, 160, v0
    v_mov_b32 v5, 5120
    v_add_u32 v35, 16896, v249
    v_cndmask_b32 v5, 0, v5, vcc
    v_add_u32 v35, v35, v5
    v_subrev_u32 v5, 320, v0
    v_lshrrev_b32 v6, 2, v5
    v_mul_u32_u24 v6, 4160, v6
    v_cmp_le_u32 vcc, 320, v0
    v_lshl_add_u32 v6, v4, 4, v6
    v_add_u32 v6, 36352, v6
    v_cndmask_b32 v35, v35, v6, vcc
    v_cmp_le_u32 vcc, 352, v0
    v_add_u32 v5, 2560, v249
    s_nop 0
    v_cndmask_b32 v35, v35, v5, vcc
    v_lshrrev_b32 v5, 1, v1
    v_lshlrev_b32 v5, 6, v5
    v_and_b32 v6, 1, v0
    v_lshl_add_u32 v37, v6, 4, v5
    v_lshrrev_b32 v5, 3, v1
    v_mul_u32_u24 v5, 80, v5
    v_mul_u32_u24 v6, 7680, v6
    v_add_u32 v5, v5, v6
    v_bfe_u32 v6, v0, 1, 2
    v_lshl_add_u32 v5, v6, 4, v5
    v_add_u32 v38, 19456, v5
    v_lshrrev_b32 v5, 1, v1
    v_lshlrev_b32 v5, 7, v5
    v_and_b32 v6, 1, v1
    v_lshl_add_u32 v43, v6, 3, v5
    v_bfe_u32 v5, v1, 3, 2
    v_lshlrev_b32 v5, 13, v5
    v_lshl_add_u32 v5, v7, 9, v5
    v_and_b32 v6, 7, v1
    v_lshl_add_u32 v29, v6, 4, v5
    v_lshlrev_b32 v5, 9, v7
    v_and_b32 v6, 15, v1
    v_lshl_add_u32 v44, v6, 4, v5
    s_mov_b32 s14, 0xffff
    s_mov_b32 s15, 0xffff
    s_mov_b32 s83, 8192
    v_mov_b64 v[2:3], 0
    v_mov_b64 v[4:5], 0
    v_and_b32 v8, 31, v1
    v_lshrrev_b32 v7, 5, v1
    v_mfma_f32_32x32x16_bf16 v[64:79], v[2:5], v[2:5], 0
    v_mfma_f32_32x32x16_bf16 v[112:127], v[2:5], v[2:5], 0
    v_mul_u32_u24 v6, 80, v8
    v_lshl_add_u32 v5, v7, 4, v6
    s_lshr_b32 s9, s5, 1
    s_and_b32 s10, s5, 1
    s_lshl_b32 s10, s10, 5
    s_mul_i32 s11, s9, 7680
    s_add_u32 s11, s11, s10
    s_add_u32 s11, s11, 16976
    v_add_u32 v39, s11, v5
    v_and_b32 v4, 3, v1
    v_xor_b32 v5, 3, v4
    v_mul_u32_u24 v5, 4160, v5
    v_lshl_add_u32 v5, v7, 4, v5
    v_lshrrev_b32 v3, 2, v8
    v_lshlrev_b32 v3, 3, v3
    v_sub_u32 v5, v5, v3
    s_mul_i32 s11, s9, 16640
    s_add_u32 s11, s11, s10
    s_add_u32 s11, s11, 32312
    v_add_u32 v40, s11, v5
    s_lshl_b32 s9, s5, 13
    s_add_u32 s9, s9, 131072
    v_add_u32 v41, s9, v15
    v_bfe_u32 v5, v0, 2, 5
    v_lshlrev_b32 v6, 2, v4
    v_xor_b32 v6, v6, v5
    v_lshlrev_b32 v6, 4, v6
    v_lshl_add_u32 v6, v4, 10, v6
    s_lshl_b32 s9, s90, 14
    s_bfe_u32 s10, s5, 0x10001
    s_lshl_b32 s11, s10, 12
    s_add_u32 s9, s9, s11
    s_add_u32 s9, s9, 131072
    v_add_u32 v249, s9, v6
    v_mul_u32_u24 v5, 80, v5
    v_lshl_add_u32 v5, v4, 4, v5
    s_mul_i32 s9, s90, 7680
    s_mul_i32 s10, s10, 2560
    s_add_u32 s9, s9, s10
    s_add_u32 s9, s9, 19456
    v_add_u32 v250, s9, v5
    s_lshr_b32 s11, s100, 1
    s_add_u32 s11, s11, 0
    v_add_u32 v45, s11, v15
    v_lshrrev_b32 v5, 3, v0
    v_and_b32 v6, 7, v0
    v_lshlrev_b32 v6, 4, v6
    v_lshl_add_u32 v251, v5, 12, v6
    v_lshrrev_b32 v5, 3, v1
    v_lshl_add_u32 v254, v5, 11, v6
    v_and_b32 v5, 48, v1
    v_bfe_u32 v6, v1, 1, 1
    v_lshl_add_u32 v5, v6, 3, v5
    v_bfe_u32 v6, v1, 2, 2
    v_add_u32 v5, v5, v6
    v_lshlrev_b32 v5, 7, v5
    v_and_b32 v6, 1, v1
    v_lshl_add_u32 v5, v6, 3, v5
    s_lshl_b32 s9, s5, 4
    s_add_u32 s9, s9, 149504
    v_add_u32 v252, s9, v5
    v_and_b32 v5, 7, v1
    v_lshrrev_b32 v6, 3, v1
    v_lshlrev_b32 v6, 4, v6
    v_lshl_add_u32 v5, v5, 7, v6
    s_mul_i32 s9, s5, 2304
    s_add_u32 s9, s9, 131072
    v_add_u32 v253, s9, v5
    v_lshlrev_b32 v255, 7, v8
    v_mov_b32 v12, 0xdddddddd
    v_and_b32 v2, 1, v1
    v_mul_u32_u24 v2, 0xaaaa, v2
    v_add_u32 v13, 0x4444, v2
    v_and_b32 v2, 27, v1
    v_cmp_eq_u32 vcc, 16, v2
    v_mov_b32 v3, 0x3f803f80
    s_lshl_b32 s9, s90, 11
    s_add_u32 s9, s9, 65536
    v_cndmask_b32 v2, 0, v3, vcc
    v_add_u32 v14, s9, v15
    v_mov_b32 v3, v2
    v_mov_b64 v[88:89], v[2:3]
    v_mov_b64 v[90:91], v[2:3]
    v_mov_b64 v[92:93], v[2:3]
    v_mov_b64 v[94:95], v[2:3]
    v_mov_b64 v[96:97], v[2:3]
    v_mov_b64 v[98:99], v[2:3]
    v_mov_b64 v[100:101], v[2:3]
    v_mov_b64 v[102:103], v[2:3]
    v_mov_b64 v[48:49], 0
    v_mov_b64 v[50:51], 0
    v_mov_b64 v[52:53], 0
    v_mov_b64 v[54:55], 0
    v_mov_b64 v[56:57], 0
    s_waitcnt lgkmcnt(0)
    s_bitcmp1_b32 s5, 1
    s_cselect_b32 s9, 0, 16
    s_lshl_b32 s9, s84, s9
    s_and_b32 s9, s9, 0xffff0000
    s_mov_b32 s86, 0x3fb8aa3b
    v_mov_b32 v2, s9
    v_mul_f32 v3, s86, v2
    v_fma_f32 v4, v2, s86, -v3
    v_fmac_f32 v4, 0x32a57060, v2
    v_exp_f32 v3, v3
    v_mul_f32 v4, 0x3f317218, v4
    v_fma_f32 v3, v3, v4, v3
    v_cvt_pk_bf16_f32 v3, v3, v3
    v_lshlrev_b32 v202, 16, v3
    s_cmp_ge_u32 s5, 4
    s_cbranch_scc1 L_xw
    s_add_u32 s12, s8, 0
    s_and_b32 s12, s12, 7
    s_lshl_b32 s12, s12, 16
    s_add_u32 m0, s100, 8192
    s_add_u32 s12, s12, s99
    buffer_load_dwordx4 v60, s[64:67], s12 offen lds
    s_add_u32 m0, s100, 9216
    s_nop 0
    buffer_load_dwordx4 v61, s[64:67], s12 offen lds
    s_add_u32 s12, s8, 1
    s_and_b32 s12, s12, 7
    s_lshl_b32 s12, s12, 16
    s_add_u32 m0, s100, 24576
    s_add_u32 s12, s12, s99
    buffer_load_dwordx4 v60, s[64:67], s12 offen lds
    s_add_u32 m0, s100, 25600
    s_nop 0
    buffer_load_dwordx4 v61, s[64:67], s12 offen lds
    s_waitcnt vmcnt(6)
    s_cmp_lg_u32 s5, 0
    s_cbranch_scc1 L_nowo
    s_lshl_b32 s9, s6, 14
    s_mov_b32 m0, 161792
    s_add_u32 s9, s9, s99
    buffer_load_dwordx4 v60, s[72:75], s9 offen lds
    s_mov_b32 m0, 162816
    s_nop 0
    buffer_load_dwordx4 v61, s[72:75], s9 offen lds
L_nowo:
    s_cmp_lg_u32 s5, 2
    s_cbranch_scc1 L_noft
    s_lshl_b32 s9, s4, 7
    s_lshl_b32 s10, s2, 3
    v_mov_b32 v2, 4849664
    v_mov_b32 v3, 4885504
    v_mov_b32 v4, 4882432
    s_mov_b64 exec, 1
    buffer_load_dword v248, v2, s[52:55], s9 offen sc1
    buffer_load_dword v248, v3, s[52:55], s9 offen sc1
    buffer_load_dword v248, v4, s[52:55], s10 offen sc1
    s_mov_b64 exec, -1
L_noft:
    s_cmp_lg_u32 s5, 1
    s_cbranch_scc1 L_pland
    s_bfe_u32 s9, s3, 0x40001
    s_lshl_b32 s9, s9, 10
    v_lshlrev_b32 v2, 7, v1
    s_mov_b64 exec, 0xff
    buffer_load_dword v248, v2, s[76:79], s9 offen
    s_mov_b64 exec, -1
    s_branch L_pland
L_xw:
    s_waitcnt vmcnt(2)
L_pland:
    v_lshlrev_b32 v192, 16, v192
    v_lshlrev_b32 v193, 16, v193
    s_cmp_lt_u32 s5, 4
    s_cselect_b32 s9, 0x41000000, 0x3f800000
    s_mov_b32 s10, 0x43800000
    s_cselect_b32 s10, 0x42000000, s10
    s_cselect_b32 s11, 0xbe22f983, 0x3e22f983
    v_mul_f32 v200, v202, v192
    v_mul_f32 v201, v202, v193
    v_mul_f32 v200, s86, v200
    v_mul_f32 v201, s11, v201
    v_mul_f32 v204, s9, v200
    v_mul_f32 v205, s9, v201
    v_mul_f32 v206, s10, v200
    v_mul_f32 v207, s10, v201
    v_exp_f32 v204, v204
    v_fract_f32 v205, v205
    v_exp_f32 v206, v206
    v_fract_f32 v207, v207
    v_cos_f32 v208, v205
    v_sin_f32 v209, v205
    v_cos_f32 v210, v207
    v_sin_f32 v211, v207
    v_pk_mul_f32 v[208:209], v[208:209], v[204:205] op_sel:[0,0] op_sel_hi:[1,0]
    v_pk_mul_f32 v[210:211], v[210:211], v[206:207] op_sel:[0,0] op_sel_hi:[1,0]
    s_cbranch_scc1 L_kgy_10
    v_lshlrev_b32 v194, 16, v194
    v_lshlrev_b32 v195, 16, v195
    v_lshlrev_b32 v196, 16, v196
    v_lshlrev_b32 v197, 16, v197
    v_pk_mul_f32 v[194:195], v[194:195], v[202:203] op_sel:[0,0] op_sel_hi:[1,0]
    v_pk_mul_f32 v[232:233], v[196:197], v[194:195] op_sel:[0,0] op_sel_hi:[0,1]
    v_pk_mul_f32 v[234:235], v[208:209], v[208:209] op_sel:[0,0] op_sel_hi:[0,1]
    v_pk_fma_f32 v[212:213], v[196:197], v[194:195], v[232:233] op_sel:[1,1,0] op_sel_hi:[1,0,1] neg_lo:[1,0,0]
    v_pk_fma_f32 v[230:231], v[208:209], v[208:209], v[234:235] op_sel:[1,1,0] op_sel_hi:[1,0,1] neg_lo:[1,0,0]
    v_pk_mul_f32 v[232:233], v[212:213], v[208:209] op_sel:[0,0] op_sel_hi:[0,1]
    v_pk_mul_f32 v[234:235], v[212:213], v[230:231] op_sel:[0,0] op_sel_hi:[0,1]
    v_pk_mul_f32 v[236:237], v[230:231], v[230:231] op_sel:[0,0] op_sel_hi:[0,1]
    v_cvt_pk_bf16_f32 v240, v212, v213
    ds_write_b32 v26, v240 offset:0
    v_pk_fma_f32 v[214:215], v[212:213], v[208:209], v[232:233] op_sel:[1,1,0] op_sel_hi:[1,0,1] neg_lo:[1,0,0]
    v_pk_fma_f32 v[216:217], v[212:213], v[230:231], v[234:235] op_sel:[1,1,0] op_sel_hi:[1,0,1] neg_lo:[1,0,0]
    v_pk_fma_f32 v[204:205], v[230:231], v[230:231], v[236:237] op_sel:[1,1,0] op_sel_hi:[1,0,1] neg_lo:[1,0,0]
    v_pk_mul_f32 v[232:233], v[214:215], v[230:231] op_sel:[0,0] op_sel_hi:[0,1]
    v_pk_mul_f32 v[234:235], v[212:213], v[204:205] op_sel:[0,0] op_sel_hi:[0,1]
    v_pk_mul_f32 v[236:237], v[214:215], v[204:205] op_sel:[0,0] op_sel_hi:[0,1]
    v_pk_mul_f32 v[238:239], v[216:217], v[204:205] op_sel:[0,0] op_sel_hi:[0,1]
    v_cvt_pk_bf16_f32 v241, v214, v215
    ds_write_b32 v26, v241 offset:544
    v_pk_fma_f32 v[218:219], v[214:215], v[230:231], v[232:233] op_sel:[1,1,0] op_sel_hi:[1,0,1] neg_lo:[1,0,0]
    v_pk_fma_f32 v[220:221], v[212:213], v[204:205], v[234:235] op_sel:[1,1,0] op_sel_hi:[1,0,1] neg_lo:[1,0,0]
    v_pk_fma_f32 v[222:223], v[214:215], v[204:205], v[236:237] op_sel:[1,1,0] op_sel_hi:[1,0,1] neg_lo:[1,0,0]
    v_pk_fma_f32 v[224:225], v[216:217], v[204:205], v[238:239] op_sel:[1,1,0] op_sel_hi:[1,0,1] neg_lo:[1,0,0]
    v_cvt_pk_bf16_f32 v242, v216, v217
    ds_write_b32 v26, v242 offset:1088
    v_pk_mul_f32 v[232:233], v[218:219], v[204:205] op_sel:[0,0] op_sel_hi:[0,1]
    v_pk_mul_f32 v[234:235], v[220:221], v[204:205] op_sel:[0,0] op_sel_hi:[0,1]
    v_pk_mul_f32 v[236:237], v[212:213], v[210:211] op_sel:[0,0] op_sel_hi:[0,1]
    v_pk_mul_f32 v[238:239], v[216:217], v[210:211] op_sel:[0,0] op_sel_hi:[0,1]
    v_cvt_pk_bf16_f32 v243, v218, v219
    ds_write_b32 v26, v243 offset:1632
    v_pk_fma_f32 v[226:227], v[218:219], v[204:205], v[232:233] op_sel:[1,1,0] op_sel_hi:[1,0,1] neg_lo:[1,0,0]
    v_pk_fma_f32 v[228:229], v[220:221], v[204:205], v[234:235] op_sel:[1,1,0] op_sel_hi:[1,0,1] neg_lo:[1,0,0]
    v_pk_fma_f32 v[212:213], v[212:213], v[210:211], v[236:237] op_sel:[1,1,0] op_sel_hi:[1,0,1] neg_lo:[1,0,0]
    v_pk_fma_f32 v[216:217], v[216:217], v[210:211], v[238:239] op_sel:[1,1,0] op_sel_hi:[1,0,1] neg_lo:[1,0,0]
    v_cvt_pk_bf16_f32 v244, v220, v221
    ds_write_b32 v26, v244 offset:2176
    v_cvt_pk_bf16_f32 v245, v222, v223
    ds_write_b32 v26, v245 offset:2720
    v_cvt_pk_bf16_f32 v246, v224, v225
    ds_write_b32 v26, v246 offset:3264
    v_pk_mul_f32 v[232:233], v[220:221], v[210:211] op_sel:[0,0] op_sel_hi:[0,1]
    v_pk_mul_f32 v[234:235], v[224:225], v[210:211] op_sel:[0,0] op_sel_hi:[0,1]
    v_pk_mul_f32 v[236:237], v[228:229], v[210:211] op_sel:[0,0] op_sel_hi:[0,1]
    v_pk_mul_f32 v[238:239], v[212:213], v[210:211] op_sel:[0,0] op_sel_hi:[0,1]
    v_cvt_pk_bf16_f32 v247, v226, v227
    ds_write_b32 v26, v247 offset:3808
    v_pk_fma_f32 v[220:221], v[220:221], v[210:211], v[232:233] op_sel:[1,1,0] op_sel_hi:[1,0,1] neg_lo:[1,0,0]
    v_pk_fma_f32 v[224:225], v[224:225], v[210:211], v[234:235] op_sel:[1,1,0] op_sel_hi:[1,0,1] neg_lo:[1,0,0]
    v_pk_fma_f32 v[228:229], v[228:229], v[210:211], v[236:237] op_sel:[1,1,0] op_sel_hi:[1,0,1] neg_lo:[1,0,0]
    v_pk_fma_f32 v[214:215], v[212:213], v[210:211], v[238:239] op_sel:[1,1,0] op_sel_hi:[1,0,1] neg_lo:[1,0,0]
    v_cvt_pk_bf16_f32 v240, v212, v213
    ds_write_b32 v26, v240 offset:4352
    v_cvt_pk_bf16_f32 v241, v216, v217
    ds_write_b32 v26, v241 offset:4896
    v_pk_mul_f32 v[232:233], v[220:221], v[210:211] op_sel:[0,0] op_sel_hi:[0,1]
    v_pk_mul_f32 v[234:235], v[228:229], v[210:211] op_sel:[0,0] op_sel_hi:[0,1]
    v_pk_mul_f32 v[236:237], v[214:215], v[210:211] op_sel:[0,0] op_sel_hi:[0,1]
    v_cvt_pk_bf16_f32 v242, v220, v221
    ds_write_b32 v26, v242 offset:5440
    ds_write_b32 v26, v242 offset:6528
    v_pk_fma_f32 v[218:219], v[220:221], v[210:211], v[232:233] op_sel:[1,1,0] op_sel_hi:[1,0,1] neg_lo:[1,0,0]
    v_pk_fma_f32 v[222:223], v[228:229], v[210:211], v[234:235] op_sel:[1,1,0] op_sel_hi:[1,0,1] neg_lo:[1,0,0]
    v_pk_fma_f32 v[212:213], v[214:215], v[210:211], v[236:237] op_sel:[1,1,0] op_sel_hi:[1,0,1] neg_lo:[1,0,0]
    v_cvt_pk_bf16_f32 v243, v224, v225
    ds_write_b32 v26, v243 offset:7072
    v_cvt_pk_bf16_f32 v244, v228, v229
    ds_write_b32 v26, v244 offset:7616
    v_cvt_pk_bf16_f32 v245, v214, v215
    ds_write_b32 v26, v245 offset:8704
    v_pk_mul_f32 v[232:233], v[218:219], v[210:211] op_sel:[0,0] op_sel_hi:[0,1]
    v_pk_mul_f32 v[234:235], v[222:223], v[210:211] op_sel:[0,0] op_sel_hi:[0,1]
    v_pk_mul_f32 v[236:237], v[212:213], v[210:211] op_sel:[0,0] op_sel_hi:[0,1]
    v_cvt_pk_bf16_f32 v246, v218, v219
    ds_write_b32 v26, v246 offset:9248
    v_pk_fma_f32 v[220:221], v[218:219], v[210:211], v[232:233] op_sel:[1,1,0] op_sel_hi:[1,0,1] neg_lo:[1,0,0]
    v_pk_fma_f32 v[228:229], v[222:223], v[210:211], v[234:235] op_sel:[1,1,0] op_sel_hi:[1,0,1] neg_lo:[1,0,0]
    v_pk_fma_f32 v[214:215], v[212:213], v[210:211], v[236:237] op_sel:[1,1,0] op_sel_hi:[1,0,1] neg_lo:[1,0,0]
    v_cvt_pk_bf16_f32 v247, v222, v223
    ds_write_b32 v26, v247 offset:9792
    v_cvt_pk_bf16_f32 v240, v212, v213
    ds_write_b32 v26, v240 offset:10880
    v_pk_mul_f32 v[232:233], v[228:229], v[210:211] op_sel:[0,0] op_sel_hi:[0,1]
    v_pk_mul_f32 v[234:235], v[214:215], v[210:211] op_sel:[0,0] op_sel_hi:[0,1]
    v_cvt_pk_bf16_f32 v241, v220, v221
    ds_write_b32 v26, v241 offset:11424
    v_pk_fma_f32 v[222:223], v[228:229], v[210:211], v[232:233] op_sel:[1,1,0] op_sel_hi:[1,0,1] neg_lo:[1,0,0]
    v_pk_fma_f32 v[212:213], v[214:215], v[210:211], v[234:235] op_sel:[1,1,0] op_sel_hi:[1,0,1] neg_lo:[1,0,0]
    v_cvt_pk_bf16_f32 v242, v228, v229
    ds_write_b32 v26, v242 offset:11968
    v_cvt_pk_bf16_f32 v243, v214, v215
    ds_write_b32 v26, v243 offset:13056
    v_pk_mul_f32 v[232:233], v[222:223], v[210:211] op_sel:[0,0] op_sel_hi:[0,1]
    v_pk_mul_f32 v[234:235], v[212:213], v[210:211] op_sel:[0,0] op_sel_hi:[0,1]
    v_cvt_pk_bf16_f32 v244, v222, v223
    ds_write_b32 v26, v244 offset:13600
    v_pk_fma_f32 v[228:229], v[222:223], v[210:211], v[232:233] op_sel:[1,1,0] op_sel_hi:[1,0,1] neg_lo:[1,0,0]
    v_pk_fma_f32 v[214:215], v[212:213], v[210:211], v[234:235] op_sel:[1,1,0] op_sel_hi:[1,0,1] neg_lo:[1,0,0]
    v_cvt_pk_bf16_f32 v245, v212, v213
    ds_write_b32 v26, v245 offset:14144
    v_pk_mul_f32 v[232:233], v[228:229], v[210:211] op_sel:[0,0] op_sel_hi:[0,1]
    v_pk_mul_f32 v[234:235], v[214:215], v[210:211] op_sel:[0,0] op_sel_hi:[0,1]
    v_cvt_pk_bf16_f32 v246, v228, v229
    ds_write_b32 v26, v246 offset:14688
    v_pk_fma_f32 v[222:223], v[228:229], v[210:211], v[232:233] op_sel:[1,1,0] op_sel_hi:[1,0,1] neg_lo:[1,0,0]
    v_pk_fma_f32 v[212:213], v[214:215], v[210:211], v[234:235] op_sel:[1,1,0] op_sel_hi:[1,0,1] neg_lo:[1,0,0]
    v_cvt_pk_bf16_f32 v247, v214, v215
    ds_write_b32 v26, v247 offset:15232
    v_pk_mul_f32 v[232:233], v[222:223], v[210:211] op_sel:[0,0] op_sel_hi:[0,1]
    v_cvt_pk_bf16_f32 v240, v222, v223
    ds_write_b32 v26, v240 offset:15776
    v_pk_fma_f32 v[228:229], v[222:223], v[210:211], v[232:233] op_sel:[1,1,0] op_sel_hi:[1,0,1] neg_lo:[1,0,0]
    v_cvt_pk_bf16_f32 v241, v212, v213
    ds_write_b32 v26, v241 offset:16320
    v_cvt_pk_bf16_f32 v242, v228, v229
    ds_write_b32 v26, v242 offset:16864
    s_branch L_kge_11
L_kgy_10:
    v_mov_b32 v240, 0x3f80
    ds_write_b32 v26, v240
    v_pk_mul_f32 v[232:233], v[208:209], v[208:209] op_sel:[0,0] op_sel_hi:[0,1]
    v_pk_mul_f32 v[234:235], v[208:209], v[210:211] op_sel:[0,0] op_sel_hi:[0,1]
    v_pk_mul_f32 v[236:237], v[210:211], v[210:211] op_sel:[0,0] op_sel_hi:[0,1]
    v_cvt_pk_bf16_f32 v241, v208, v209
    ds_write_b32 v26, v241 offset:544
    v_pk_fma_f32 v[216:217], v[208:209], v[208:209], v[232:233] op_sel:[1,1,0] op_sel_hi:[1,0,1] neg_lo:[1,0,0]
    v_pk_fma_f32 v[222:223], v[208:209], v[210:211], v[234:235] op_sel:[1,1,0] op_sel_hi:[1,0,1] neg_lo:[1,0,0]
    v_pk_fma_f32 v[212:213], v[210:211], v[210:211], v[236:237] op_sel:[1,1,0] op_sel_hi:[1,0,1] neg_lo:[1,0,0]
    v_cvt_pk_bf16_f32 v242, v210, v211
    ds_write_b32 v26, v242 offset:2176
    v_pk_mul_f32 v[232:233], v[216:217], v[208:209] op_sel:[0,0] op_sel_hi:[0,1]
    v_pk_mul_f32 v[234:235], v[216:217], v[210:211] op_sel:[0,0] op_sel_hi:[0,1]
    v_pk_mul_f32 v[236:237], v[222:223], v[210:211] op_sel:[0,0] op_sel_hi:[0,1]
    v_pk_mul_f32 v[238:239], v[212:213], v[210:211] op_sel:[0,0] op_sel_hi:[0,1]
    v_cvt_pk_bf16_f32 v243, v216, v217
    ds_write_b32 v26, v243 offset:1088
    v_pk_fma_f32 v[218:219], v[216:217], v[208:209], v[232:233] op_sel:[1,1,0] op_sel_hi:[1,0,1] neg_lo:[1,0,0]
    v_pk_fma_f32 v[224:225], v[216:217], v[210:211], v[234:235] op_sel:[1,1,0] op_sel_hi:[1,0,1] neg_lo:[1,0,0]
    v_pk_fma_f32 v[214:215], v[222:223], v[210:211], v[236:237] op_sel:[1,1,0] op_sel_hi:[1,0,1] neg_lo:[1,0,0]
    v_pk_fma_f32 v[220:221], v[212:213], v[210:211], v[238:239] op_sel:[1,1,0] op_sel_hi:[1,0,1] neg_lo:[1,0,0]
    v_cvt_pk_bf16_f32 v244, v222, v223
    ds_write_b32 v26, v244 offset:2720
    v_cvt_pk_bf16_f32 v245, v212, v213
    ds_write_b32 v26, v245 offset:4352
    v_pk_mul_f32 v[232:233], v[218:219], v[210:211] op_sel:[0,0] op_sel_hi:[0,1]
    v_pk_mul_f32 v[234:235], v[224:225], v[210:211] op_sel:[0,0] op_sel_hi:[0,1]
    v_pk_mul_f32 v[236:237], v[214:215], v[210:211] op_sel:[0,0] op_sel_hi:[0,1]
    v_pk_mul_f32 v[238:239], v[220:221], v[210:211] op_sel:[0,0] op_sel_hi:[0,1]
    v_cvt_pk_bf16_f32 v246, v218, v219
    ds_write_b32 v26, v246 offset:1632
    v_pk_fma_f32 v[226:227], v[218:219], v[210:211], v[232:233] op_sel:[1,1,0] op_sel_hi:[1,0,1] neg_lo:[1,0,0]
    v_pk_fma_f32 v[216:217], v[224:225], v[210:211], v[234:235] op_sel:[1,1,0] op_sel_hi:[1,0,1] neg_lo:[1,0,0]
    v_pk_fma_f32 v[222:223], v[214:215], v[210:211], v[236:237] op_sel:[1,1,0] op_sel_hi:[1,0,1] neg_lo:[1,0,0]
    v_pk_fma_f32 v[212:213], v[220:221], v[210:211], v[238:239] op_sel:[1,1,0] op_sel_hi:[1,0,1] neg_lo:[1,0,0]
    v_cvt_pk_bf16_f32 v247, v224, v225
    ds_write_b32 v26, v247 offset:3264
    v_cvt_pk_bf16_f32 v240, v214, v215
    ds_write_b32 v26, v240 offset:4896
    v_cvt_pk_bf16_f32 v241, v220, v221
    ds_write_b32 v26, v241 offset:6528
    v_pk_mul_f32 v[232:233], v[226:227], v[210:211] op_sel:[0,0] op_sel_hi:[0,1]
    v_pk_mul_f32 v[234:235], v[216:217], v[210:211] op_sel:[0,0] op_sel_hi:[0,1]
    v_pk_mul_f32 v[236:237], v[222:223], v[210:211] op_sel:[0,0] op_sel_hi:[0,1]
    v_pk_mul_f32 v[238:239], v[212:213], v[210:211] op_sel:[0,0] op_sel_hi:[0,1]
    v_cvt_pk_bf16_f32 v242, v226, v227
    ds_write_b32 v26, v242 offset:3808
    v_pk_fma_f32 v[218:219], v[226:227], v[210:211], v[232:233] op_sel:[1,1,0] op_sel_hi:[1,0,1] neg_lo:[1,0,0]
    v_pk_fma_f32 v[224:225], v[216:217], v[210:211], v[234:235] op_sel:[1,1,0] op_sel_hi:[1,0,1] neg_lo:[1,0,0]
    v_pk_fma_f32 v[214:215], v[222:223], v[210:211], v[236:237] op_sel:[1,1,0] op_sel_hi:[1,0,1] neg_lo:[1,0,0]
    v_pk_fma_f32 v[220:221], v[212:213], v[210:211], v[238:239] op_sel:[1,1,0] op_sel_hi:[1,0,1] neg_lo:[1,0,0]
    v_cvt_pk_bf16_f32 v243, v216, v217
    ds_write_b32 v26, v243 offset:5440
    v_cvt_pk_bf16_f32 v244, v222, v223
    ds_write_b32 v26, v244 offset:7072
    v_cvt_pk_bf16_f32 v245, v212, v213
    ds_write_b32 v26, v245 offset:8704
    v_pk_mul_f32 v[232:233], v[218:219], v[210:211] op_sel:[0,0] op_sel_hi:[0,1]
    v_pk_mul_f32 v[234:235], v[224:225], v[210:211] op_sel:[0,0] op_sel_hi:[0,1]
    v_pk_mul_f32 v[236:237], v[214:215], v[210:211] op_sel:[0,0] op_sel_hi:[0,1]
    v_pk_mul_f32 v[238:239], v[220:221], v[210:211] op_sel:[0,0] op_sel_hi:[0,1]
    v_cvt_pk_bf16_f32 v246, v218, v219
    ds_write_b32 v26, v246 offset:5984
    v_pk_fma_f32 v[226:227], v[218:219], v[210:211], v[232:233] op_sel:[1,1,0] op_sel_hi:[1,0,1] neg_lo:[1,0,0]
    v_pk_fma_f32 v[216:217], v[224:225], v[210:211], v[234:235] op_sel:[1,1,0] op_sel_hi:[1,0,1] neg_lo:[1,0,0]
    v_pk_fma_f32 v[222:223], v[214:215], v[210:211], v[236:237] op_sel:[1,1,0] op_sel_hi:[1,0,1] neg_lo:[1,0,0]
    v_pk_fma_f32 v[212:213], v[220:221], v[210:211], v[238:239] op_sel:[1,1,0] op_sel_hi:[1,0,1] neg_lo:[1,0,0]
    v_cvt_pk_bf16_f32 v247, v224, v225
    ds_write_b32 v26, v247 offset:7616
    v_cvt_pk_bf16_f32 v240, v214, v215
    ds_write_b32 v26, v240 offset:9248
    v_cvt_pk_bf16_f32 v241, v220, v221
    ds_write_b32 v26, v241 offset:10880
    v_pk_mul_f32 v[232:233], v[226:227], v[210:211] op_sel:[0,0] op_sel_hi:[0,1]
    v_pk_mul_f32 v[234:235], v[216:217], v[210:211] op_sel:[0,0] op_sel_hi:[0,1]
    v_pk_mul_f32 v[236:237], v[222:223], v[210:211] op_sel:[0,0] op_sel_hi:[0,1]
    v_pk_mul_f32 v[238:239], v[212:213], v[210:211] op_sel:[0,0] op_sel_hi:[0,1]
    v_cvt_pk_bf16_f32 v242, v226, v227
    ds_write_b32 v26, v242 offset:8160
    v_pk_fma_f32 v[218:219], v[226:227], v[210:211], v[232:233] op_sel:[1,1,0] op_sel_hi:[1,0,1] neg_lo:[1,0,0]
    v_pk_fma_f32 v[224:225], v[216:217], v[210:211], v[234:235] op_sel:[1,1,0] op_sel_hi:[1,0,1] neg_lo:[1,0,0]
    v_pk_fma_f32 v[214:215], v[222:223], v[210:211], v[236:237] op_sel:[1,1,0] op_sel_hi:[1,0,1] neg_lo:[1,0,0]
    v_pk_fma_f32 v[220:221], v[212:213], v[210:211], v[238:239] op_sel:[1,1,0] op_sel_hi:[1,0,1] neg_lo:[1,0,0]
    v_cvt_pk_bf16_f32 v243, v216, v217
    ds_write_b32 v26, v243 offset:9792
    v_cvt_pk_bf16_f32 v244, v222, v223
    ds_write_b32 v26, v244 offset:11424
    v_cvt_pk_bf16_f32 v245, v212, v213
    ds_write_b32 v26, v245 offset:13056
    v_pk_mul_f32 v[232:233], v[218:219], v[210:211] op_sel:[0,0] op_sel_hi:[0,1]
    v_pk_mul_f32 v[234:235], v[224:225], v[210:211] op_sel:[0,0] op_sel_hi:[0,1]
    v_pk_mul_f32 v[236:237], v[214:215], v[210:211] op_sel:[0,0] op_sel_hi:[0,1]
    v_cvt_pk_bf16_f32 v246, v218, v219
    ds_write_b32 v26, v246 offset:10336
    v_pk_fma_f32 v[226:227], v[218:219], v[210:211], v[232:233] op_sel:[1,1,0] op_sel_hi:[1,0,1] neg_lo:[1,0,0]
    v_pk_fma_f32 v[216:217], v[224:225], v[210:211], v[234:235] op_sel:[1,1,0] op_sel_hi:[1,0,1] neg_lo:[1,0,0]
    v_pk_fma_f32 v[222:223], v[214:215], v[210:211], v[236:237] op_sel:[1,1,0] op_sel_hi:[1,0,1] neg_lo:[1,0,0]
    v_cvt_pk_bf16_f32 v247, v224, v225
    ds_write_b32 v26, v247 offset:11968
    v_cvt_pk_bf16_f32 v240, v214, v215
    ds_write_b32 v26, v240 offset:13600
    v_cvt_pk_bf16_f32 v241, v220, v221
    ds_write_b32 v26, v241 offset:15232
    v_pk_mul_f32 v[232:233], v[226:227], v[210:211] op_sel:[0,0] op_sel_hi:[0,1]
    v_pk_mul_f32 v[234:235], v[216:217], v[210:211] op_sel:[0,0] op_sel_hi:[0,1]
    v_cvt_pk_bf16_f32 v242, v226, v227
    ds_write_b32 v26, v242 offset:12512
    v_pk_fma_f32 v[218:219], v[226:227], v[210:211], v[232:233] op_sel:[1,1,0] op_sel_hi:[1,0,1] neg_lo:[1,0,0]
    v_pk_fma_f32 v[224:225], v[216:217], v[210:211], v[234:235] op_sel:[1,1,0] op_sel_hi:[1,0,1] neg_lo:[1,0,0]
    v_cvt_pk_bf16_f32 v243, v216, v217
    ds_write_b32 v26, v243 offset:14144
    v_cvt_pk_bf16_f32 v244, v222, v223
    ds_write_b32 v26, v244 offset:15776
    v_pk_mul_f32 v[232:233], v[218:219], v[210:211] op_sel:[0,0] op_sel_hi:[0,1]
    v_cvt_pk_bf16_f32 v245, v218, v219
    ds_write_b32 v26, v245 offset:14688
    v_pk_fma_f32 v[226:227], v[218:219], v[210:211], v[232:233] op_sel:[1,1,0] op_sel_hi:[1,0,1] neg_lo:[1,0,0]
    v_cvt_pk_bf16_f32 v246, v224, v225
    ds_write_b32 v26, v246 offset:16320
    v_cvt_pk_bf16_f32 v247, v226, v227
    ds_write_b32 v26, v247 offset:16864
L_kge_11:
    s_cmp_lt_u32 s5, 4
    s_cbranch_scc1 L_nou
    s_waitcnt vmcnt(0)
    v_xor_b32 v6, 64, v27
    ds_read_b64_tr_b16 v[2:3], v27
    ds_read_b64_tr_b16 v[4:5], v27 offset:512
    ds_read_b64_tr_b16 v[194:195], v6
    ds_read_b64_tr_b16 v[196:197], v6 offset:512
    s_lshr_b32 s9, s3, 5
    s_lshl_b32 s9, s9, 18
    s_and_b32 s10, s3, 31
    s_lshl_b32 s10, s10, 9
    s_add_u32 s9, s9, s10
    s_lshr_b32 s10, s100, 4
    s_add_u32 s9, s9, s10
    s_add_u32 s9, s9, 2097152
    s_add_u32 s10, s9, 131072
    s_waitcnt lgkmcnt(2)
    buffer_store_dwordx4 v[2:5], v28, s[52:55], s9 offen sc1
    s_waitcnt lgkmcnt(0)
    buffer_store_dwordx4 v[194:197], v28, s[52:55], s10 offen sc1
L_nou:
    s_waitcnt lgkmcnt(0)
    s_barrier
    ds_read_b128 v[144:147], v24 offset:0
    ds_read_b128 v[148:151], v25 offset:0
    ds_read_b128 v[152:155], v24 offset:64
    ds_read_b128 v[156:159], v25 offset:64
    ds_read_b128 v[160:163], v24 offset:128
    ds_read_b128 v[164:167], v25 offset:128
    ds_read_b128 v[168:171], v24 offset:192
    ds_read_b128 v[172:175], v25 offset:192
    ds_read_b128 v[176:179], v24 offset:256
    ds_read_b128 v[180:183], v25 offset:256
    ds_read_b128 v[184:187], v24 offset:320
    ds_read_b128 v[188:191], v25 offset:320
    ds_read_b128 v[192:195], v24 offset:384
    ds_read_b128 v[196:199], v25 offset:384
    s_waitcnt lgkmcnt(12)
    v_mfma_f32_16x16x32_bf16 v[104:107], v[144:147], v[148:151], 0
    ds_read_b128 v[144:147], v24 offset:448
    ds_read_b128 v[148:151], v25 offset:448
    s_waitcnt lgkmcnt(12)
    v_mfma_f32_16x16x32_bf16 v[104:107], v[152:155], v[156:159], v[104:107]
    s_waitcnt lgkmcnt(10)
    v_mfma_f32_16x16x32_bf16 v[104:107], v[160:163], v[164:167], v[104:107]
    s_waitcnt lgkmcnt(8)
    v_mfma_f32_16x16x32_bf16 v[104:107], v[168:171], v[172:175], v[104:107]
    s_waitcnt lgkmcnt(6)
    v_mfma_f32_16x16x32_bf16 v[104:107], v[176:179], v[180:183], v[104:107]
    s_waitcnt lgkmcnt(4)
    v_mfma_f32_16x16x32_bf16 v[104:107], v[184:187], v[188:191], v[104:107]
    s_waitcnt lgkmcnt(2)
    v_mfma_f32_16x16x32_bf16 v[104:107], v[192:195], v[196:199], v[104:107]
    s_waitcnt lgkmcnt(0)
    v_mfma_f32_16x16x32_bf16 v[104:107], v[144:147], v[148:151], v[104:107]
    v_readfirstlane_b32 s9, v11
    s_mul_i32 s9, s9, 0x0019660d
    s_add_u32 s9, s9, 0x3c6ef35f
    s_cmp_eq_u32 s50, 0
    s_cselect_b32 s51, s9, s51
    v_mov_b32 v85, 0
    v_mov_b32 v86, 0
    s_nop 1
    v_cvt_pk_bf16_f32 v2, v104, v105
    v_cvt_pk_bf16_f32 v3, v106, v107
    v_perm_b32 v200, v3, v2, v31
    v_perm_b32 v201, v3, v2, v32
    s_bitcmp1_b32 s5, 1
    s_cbranch_scc1 L_rt1_12
    ds_write_b64 v30, v[200:201] offset:4088
    s_branch L_c0e_13
L_rt1_12:
    v_perm_b32 v202, v3, v2, v33
    v_perm_b32 v203, v3, v2, v34
    ds_write_b128 v30, v[200:203] offset:4080
    v_perm_b32 v204, v2, v3, v31
    v_perm_b32 v205, v2, v3, v32
    v_perm_b32 v206, v2, v3, v33
    v_perm_b32 v207, v2, v3, v34
    s_mov_b32 exec_lo, 0
    ds_write_b128 v30, v[204:207] offset:3568
    s_mov_b32 exec_lo, -1
L_c0e_13:
    s_waitcnt lgkmcnt(0)
    s_barrier
    ds_read_b128 v[208:211], v42
    ds_read_b64 v[212:213], v42 offset:16
    s_cmp_ge_u32 s5, 4
    s_cbranch_scc1 L_gload
    s_waitcnt lgkmcnt(0)
    v_and_b32 v2, 255, v0
    v_cmp_ne_u32 vcc, 255, v2
    s_nop 1
    v_cndmask_b32 v212, 0, v212, vcc
    v_cndmask_b32 v213, 0, v213, vcc
    v_alignbit_b32 v216, v209, v208, 16
    v_alignbit_b32 v217, v210, v209, 16
    v_alignbit_b32 v218, v211, v210, 16
    v_alignbit_b32 v219, v212, v211, 16
    v_mov_b32 v220, v209
    v_mov_b32 v221, v210
    v_mov_b32 v222, v211
    v_mov_b32 v223, v212
    v_alignbit_b32 v224, v210, v209, 16
    v_alignbit_b32 v225, v211, v210, 16
    v_alignbit_b32 v226, v212, v211, 16
    v_alignbit_b32 v227, v213, v212, 16
    s_waitcnt vmcnt(0)
    s_barrier
    ds_read_b64_tr_b16 v[144:145], v18 offset:0
    ds_read_b64_tr_b16 v[146:147], v18 offset:512
    ds_read_b128 v[148:151], v19 offset:0
    ds_read_b64_tr_b16 v[152:153], v18 offset:2048
    ds_read_b64_tr_b16 v[154:155], v18 offset:2560
    ds_read_b128 v[156:159], v20 offset:0
    ds_read_b64_tr_b16 v[160:161], v18 offset:4096
    ds_read_b64_tr_b16 v[162:163], v18 offset:4608
    ds_read_b128 v[164:167], v21 offset:0
    ds_read_b64_tr_b16 v[168:169], v18 offset:6144
    ds_read_b64_tr_b16 v[170:171], v18 offset:6656
    ds_read_b128 v[172:175], v22 offset:0
    ds_read_b64_tr_b16 v[176:177], v18 offset:16384
    ds_read_b64_tr_b16 v[178:179], v18 offset:16896
    ds_read_b128 v[180:183], v19 offset:16384
    s_waitcnt lgkmcnt(12)
    v_mfma_f32_32x32x16_bf16 v[128:143], v[144:147], v[148:151], 0
    ds_read_b64_tr_b16 v[184:185], v18 offset:18432
    ds_read_b64_tr_b16 v[186:187], v18 offset:18944
    ds_read_b128 v[188:191], v20 offset:16384
    s_waitcnt lgkmcnt(12)
    v_mfma_f32_32x32x16_bf16 v[128:143], v[152:155], v[156:159], v[128:143]
    ds_read_b64_tr_b16 v[144:145], v18 offset:20480
    ds_read_b64_tr_b16 v[146:147], v18 offset:20992
    ds_read_b128 v[148:151], v21 offset:16384
    s_waitcnt lgkmcnt(12)
    v_mfma_f32_32x32x16_bf16 v[128:143], v[160:163], v[164:167], v[128:143]
    ds_read_b64_tr_b16 v[152:153], v18 offset:22528
    ds_read_b64_tr_b16 v[154:155], v18 offset:23040
    ds_read_b128 v[156:159], v22 offset:16384
    s_waitcnt lgkmcnt(12)
    v_mfma_f32_32x32x16_bf16 v[128:143], v[168:171], v[172:175], v[128:143]
    s_waitcnt lgkmcnt(9)
    v_mfma_f32_32x32x16_bf16 v[128:143], v[176:179], v[180:183], v[128:143]
    s_waitcnt lgkmcnt(6)
    v_mfma_f32_32x32x16_bf16 v[128:143], v[184:187], v[188:191], v[128:143]
    s_waitcnt lgkmcnt(3)
    v_mfma_f32_32x32x16_bf16 v[128:143], v[144:147], v[148:151], v[128:143]
    s_waitcnt lgkmcnt(0)
    v_mfma_f32_32x32x16_bf16 v[128:143], v[152:155], v[156:159], v[128:143]
    s_barrier
    ds_read_b64_tr_b16 v[144:145], v18 offset:32768
    ds_read_b64_tr_b16 v[146:147], v18 offset:33280
    ds_read_b128 v[148:151], v19 offset:32768
    ds_read_b64_tr_b16 v[152:153], v18 offset:34816
    ds_read_b64_tr_b16 v[154:155], v18 offset:35328
    ds_read_b128 v[156:159], v20 offset:32768
    ds_read_b64_tr_b16 v[160:161], v18 offset:36864
    ds_read_b64_tr_b16 v[162:163], v18 offset:37376
    ds_read_b128 v[164:167], v21 offset:32768
    ds_read_b64_tr_b16 v[168:169], v18 offset:38912
    ds_read_b64_tr_b16 v[170:171], v18 offset:39424
    ds_read_b128 v[172:175], v22 offset:32768
    ds_read_b64_tr_b16 v[176:177], v18 offset:49152
    ds_read_b64_tr_b16 v[178:179], v18 offset:49664
    ds_read_b128 v[180:183], v19 offset:49152
    s_waitcnt lgkmcnt(12)
    v_mfma_f32_32x32x16_bf16 v[128:143], v[144:147], v[148:151], v[128:143]
    ds_read_b64_tr_b16 v[184:185], v18 offset:51200
    ds_read_b64_tr_b16 v[186:187], v18 offset:51712
    ds_read_b128 v[188:191], v20 offset:49152
    s_waitcnt lgkmcnt(12)
    v_mfma_f32_32x32x16_bf16 v[128:143], v[152:155], v[156:159], v[128:143]
    ds_read_b64_tr_b16 v[144:145], v18 offset:53248
    ds_read_b64_tr_b16 v[146:147], v18 offset:53760
    ds_read_b128 v[148:151], v21 offset:49152
    s_waitcnt lgkmcnt(12)
    v_mfma_f32_32x32x16_bf16 v[128:143], v[160:163], v[164:167], v[128:143]
    ds_read_b64_tr_b16 v[152:153], v18 offset:55296
    ds_read_b64_tr_b16 v[154:155], v18 offset:55808
    ds_read_b128 v[156:159], v22 offset:49152
    s_waitcnt lgkmcnt(12)
    v_mfma_f32_32x32x16_bf16 v[128:143], v[168:171], v[172:175], v[128:143]
    s_waitcnt lgkmcnt(9)
    v_mfma_f32_32x32x16_bf16 v[128:143], v[176:179], v[180:183], v[128:143]
    s_waitcnt lgkmcnt(6)
    v_mfma_f32_32x32x16_bf16 v[128:143], v[184:187], v[188:191], v[128:143]
    s_waitcnt lgkmcnt(3)
    v_mfma_f32_32x32x16_bf16 v[128:143], v[144:147], v[148:151], v[128:143]
    s_waitcnt lgkmcnt(0)
    v_mfma_f32_32x32x16_bf16 v[128:143], v[152:155], v[156:159], v[128:143]
    v_add_u32 v18, 0x10000, v18
    v_add_u32 v19, 0x10000, v19
    v_add_u32 v20, 0x10000, v20
    v_add_u32 v21, 0x10000, v21
    v_add_u32 v22, 0x10000, v22
    s_barrier
    ds_read_b64_tr_b16 v[144:145], v18 offset:0
    ds_read_b64_tr_b16 v[146:147], v18 offset:512
    ds_read_b128 v[148:151], v19 offset:0
    ds_read_b64_tr_b16 v[152:153], v18 offset:2048
    ds_read_b64_tr_b16 v[154:155], v18 offset:2560
    ds_read_b128 v[156:159], v20 offset:0
    ds_read_b64_tr_b16 v[160:161], v18 offset:4096
    ds_read_b64_tr_b16 v[162:163], v18 offset:4608
    ds_read_b128 v[164:167], v21 offset:0
    ds_read_b64_tr_b16 v[168:169], v18 offset:6144
    ds_read_b64_tr_b16 v[170:171], v18 offset:6656
    ds_read_b128 v[172:175], v22 offset:0
    ds_read_b64_tr_b16 v[176:177], v18 offset:16384
    ds_read_b64_tr_b16 v[178:179], v18 offset:16896
    ds_read_b128 v[180:183], v19 offset:16384
    s_waitcnt lgkmcnt(12)
    v_mfma_f32_32x32x16_bf16 v[128:143], v[144:147], v[148:151], v[128:143]
    ds_read_b64_tr_b16 v[184:185], v18 offset:18432
    ds_read_b64_tr_b16 v[186:187], v18 offset:18944
    ds_read_b128 v[188:191], v20 offset:16384
    s_waitcnt lgkmcnt(12)
    v_mfma_f32_32x32x16_bf16 v[128:143], v[152:155], v[156:159], v[128:143]
    ds_read_b64_tr_b16 v[144:145], v18 offset:20480
    ds_read_b64_tr_b16 v[146:147], v18 offset:20992
    ds_read_b128 v[148:151], v21 offset:16384
    s_waitcnt lgkmcnt(12)
    v_mfma_f32_32x32x16_bf16 v[128:143], v[160:163], v[164:167], v[128:143]
    ds_read_b64_tr_b16 v[152:153], v18 offset:22528
    ds_read_b64_tr_b16 v[154:155], v18 offset:23040
    ds_read_b128 v[156:159], v22 offset:16384
    s_waitcnt lgkmcnt(12)
    v_mfma_f32_32x32x16_bf16 v[128:143], v[168:171], v[172:175], v[128:143]
    s_waitcnt lgkmcnt(9)
    v_mfma_f32_32x32x16_bf16 v[128:143], v[176:179], v[180:183], v[128:143]
    s_waitcnt lgkmcnt(6)
    v_mfma_f32_32x32x16_bf16 v[128:143], v[184:187], v[188:191], v[128:143]
    s_waitcnt lgkmcnt(3)
    v_mfma_f32_32x32x16_bf16 v[128:143], v[144:147], v[148:151], v[128:143]
    s_waitcnt lgkmcnt(0)
    v_mfma_f32_32x32x16_bf16 v[128:143], v[152:155], v[156:159], v[128:143]
    s_barrier
    ds_read_b64_tr_b16 v[144:145], v18 offset:32768
    ds_read_b64_tr_b16 v[146:147], v18 offset:33280
    ds_read_b128 v[148:151], v19 offset:32768
    ds_read_b64_tr_b16 v[152:153], v18 offset:34816
    ds_read_b64_tr_b16 v[154:155], v18 offset:35328
    ds_read_b128 v[156:159], v20 offset:32768
    ds_read_b64_tr_b16 v[160:161], v18 offset:36864
    ds_read_b64_tr_b16 v[162:163], v18 offset:37376
    ds_read_b128 v[164:167], v21 offset:32768
    ds_read_b64_tr_b16 v[168:169], v18 offset:38912
    ds_read_b64_tr_b16 v[170:171], v18 offset:39424
    ds_read_b128 v[172:175], v22 offset:32768
    ds_read_b64_tr_b16 v[176:177], v18 offset:49152
    ds_read_b64_tr_b16 v[178:179], v18 offset:49664
    ds_read_b128 v[180:183], v19 offset:49152
    s_waitcnt lgkmcnt(12)
    v_mfma_f32_32x32x16_bf16 v[128:143], v[144:147], v[148:151], v[128:143]
    ds_read_b64_tr_b16 v[184:185], v18 offset:51200
    ds_read_b64_tr_b16 v[186:187], v18 offset:51712
    ds_read_b128 v[188:191], v20 offset:49152
    s_waitcnt lgkmcnt(12)
    v_mfma_f32_32x32x16_bf16 v[128:143], v[152:155], v[156:159], v[128:143]
    ds_read_b64_tr_b16 v[144:145], v18 offset:53248
    ds_read_b64_tr_b16 v[146:147], v18 offset:53760
    ds_read_b128 v[148:151], v21 offset:49152
    s_waitcnt lgkmcnt(12)
    v_mfma_f32_32x32x16_bf16 v[128:143], v[160:163], v[164:167], v[128:143]
    ds_read_b64_tr_b16 v[152:153], v18 offset:55296
    ds_read_b64_tr_b16 v[154:155], v18 offset:55808
    ds_read_b128 v[156:159], v22 offset:49152
    s_waitcnt lgkmcnt(12)
    v_mfma_f32_32x32x16_bf16 v[128:143], v[168:171], v[172:175], v[128:143]
    s_waitcnt lgkmcnt(9)
    v_mfma_f32_32x32x16_bf16 v[128:143], v[176:179], v[180:183], v[128:143]
    s_waitcnt lgkmcnt(6)
    v_mfma_f32_32x32x16_bf16 v[128:143], v[184:187], v[188:191], v[128:143]
    s_waitcnt lgkmcnt(3)
    v_mfma_f32_32x32x16_bf16 v[128:143], v[144:147], v[148:151], v[128:143]
    s_waitcnt lgkmcnt(0)
    v_mfma_f32_32x32x16_bf16 v[128:143], v[152:155], v[156:159], v[128:143]
    s_lshr_b32 s10, s5, 1
    s_lshl_b32 s10, s10, 15
    s_add_u32 s9, s98, s10
    s_lshl_b32 s10, s7, 10
    s_add_u32 s9, s9, s10
    s_and_b32 s10, s5, 1
    s_lshl_b32 s10, s10, 8
    s_add_u32 s9, s9, s10
    s_nop 3
    v_cvt_pk_bf16_f32 v144, v128, v129
    v_cvt_pk_bf16_f32 v145, v130, v131
    v_cvt_pk_bf16_f32 v146, v132, v133
    v_cvt_pk_bf16_f32 v147, v134, v135
    buffer_store_dwordx4 v[144:147], v29, s[52:55], s9 offen sc1
    v_cvt_pk_bf16_f32 v148, v136, v137
    v_cvt_pk_bf16_f32 v149, v138, v139
    v_cvt_pk_bf16_f32 v150, v140, v141
    v_cvt_pk_bf16_f32 v151, v142, v143
    buffer_store_dwordx4 v[148:151], v29, s[52:55], s9 offen offset:128 sc1
    v_dot2_f32_bf16 v2, v144, v144, 0
    v_dot2_f32_bf16 v3, v148, v148, 0
    v_dot2_f32_bf16 v2, v145, v145, v2
    v_dot2_f32_bf16 v3, v149, v149, v3
    v_dot2_f32_bf16 v2, v146, v146, v2
    v_dot2_f32_bf16 v3, v150, v150, v3
    v_dot2_f32_bf16 v2, v147, v147, v2
    v_dot2_f32_bf16 v3, v151, v151, v3
    s_nop 2
    v_max_u32 v85, v2, v3
    v_mov_b64 v[4:5], 0
    v_mov_b64 v[6:7], 0
    ds_write_b128 v36, v[208:211]
    ds_write_b128 v36, v[216:219] offset:4160
    ds_write_b128 v36, v[220:223] offset:8320
    ds_write_b128 v36, v[224:227] offset:12480
    ds_write_b128 v35, v[4:7]
    s_branch L_gjoin
L_gload:
    s_lshr_b32 s9, s100, 10
    s_add_u32 s9, s9, s8
    s_add_u32 s9, s9, 0
    s_and_b32 s9, s9, 7
    s_lshl_b32 s10, s100, 1
    s_add_u32 m0, s10, 135168
    s_lshl_b32 s9, s9, 11
    buffer_load_dwordx4 v15, s[76:79], s9 offen lds
    buffer_load_dwordx4 v15, s[76:79], s9 offen offset:1024 lds
    s_lshr_b32 s9, s100, 10
    s_add_u32 s9, s9, s8
    s_add_u32 s9, s9, 1
    s_and_b32 s9, s9, 7
    s_lshl_b32 s10, s100, 1
    s_add_u32 m0, s10, 137216
    s_lshl_b32 s9, s9, 11
    buffer_load_dwordx4 v15, s[76:79], s9 offen lds
    buffer_load_dwordx4 v15, s[76:79], s9 offen offset:1024 lds
    s_add_u32 s12, s8, 1
    s_and_b32 s12, s12, 7
    s_lshl_b32 s12, s12, 7
    s_add_u32 m0, s100, 16384
    s_add_u32 s12, s12, s98
    buffer_load_dwordx4 v58, s[60:63], s12 offen lds
    s_add_u32 m0, s100, 17408
    s_nop 0
    buffer_load_dwordx4 v59, s[60:63], s12 offen lds
    s_add_u32 s12, s8, 2
    s_and_b32 s12, s12, 7
    s_lshl_b32 s12, s12, 7
    s_add_u32 m0, s100, 32768
    s_add_u32 s12, s12, s98
    buffer_load_dwordx4 v58, s[60:63], s12 offen lds
    s_add_u32 m0, s100, 33792
    s_nop 0
    buffer_load_dwordx4 v59, s[60:63], s12 offen lds
    s_add_u32 s12, s8, 2
    s_and_b32 s12, s12, 7
    s_lshl_b32 s12, s12, 16
    s_add_u32 m0, s100, 40960
    s_add_u32 s12, s12, s99
    buffer_load_dwordx4 v60, s[64:67], s12 offen lds
    s_add_u32 m0, s100, 41984
    s_nop 0
    buffer_load_dwordx4 v61, s[64:67], s12 offen lds
    s_add_u32 s12, s8, 3
    s_and_b32 s12, s12, 7
    s_lshl_b32 s12, s12, 7
    s_add_u32 m0, s100, 49152
    s_add_u32 s12, s12, s98
    buffer_load_dwordx4 v58, s[60:63], s12 offen lds
    s_add_u32 m0, s100, 50176
    s_nop 0
    buffer_load_dwordx4 v59, s[60:63], s12 offen lds
    s_add_u32 s12, s8, 3
    s_and_b32 s12, s12, 7
    s_lshl_b32 s12, s12, 16
    s_add_u32 m0, s100, 57344
    s_add_u32 s12, s12, s99
    buffer_load_dwordx4 v60, s[64:67], s12 offen lds
    s_add_u32 m0, s100, 58368
    s_nop 0
    buffer_load_dwordx4 v61, s[64:67], s12 offen lds
    s_waitcnt vmcnt(8)
    s_lshl_b32 s9, s50, 4
    s_add_u32 s9, s9, s5
    s_sub_u32 s9, s9, 4
    s_cmp_ge_u32 s9, 4
    s_cbranch_scc1 L_nofl_14
    s_lshl_b32 s10, s4, 5
    s_add_u32 s9, s9, s10
    s_lshl_b32 s9, s9, 2
    s_add_u32 s9, s9, 4849664
    v_mov_b32 v2, 0
    v_mov_b32 v3, s51
    s_waitcnt vmcnt(8)
    s_mov_b64 exec, 1
    buffer_store_dword v3, v2, s[52:55], s9 offen sc1
    s_mov_b64 exec, -1
L_nofl_14:
    s_barrier
    s_add_u32 s12, s8, 4
    s_and_b32 s12, s12, 7
    s_lshl_b32 s12, s12, 7
    s_add_u32 m0, s100, 65536
    s_add_u32 s12, s12, s98
    buffer_load_dwordx4 v58, s[60:63], s12 offen lds
    s_add_u32 m0, s100, 66560
    s_nop 0
    buffer_load_dwordx4 v59, s[60:63], s12 offen lds
    s_add_u32 s12, s8, 4
    s_and_b32 s12, s12, 7
    s_lshl_b32 s12, s12, 16
    s_add_u32 m0, s100, 73728
    s_add_u32 s12, s12, s99
    buffer_load_dwordx4 v60, s[64:67], s12 offen lds
    s_add_u32 m0, s100, 74752
    s_nop 0
    buffer_load_dwordx4 v61, s[64:67], s12 offen lds
    s_add_u32 s12, s8, 5
    s_and_b32 s12, s12, 7
    s_lshl_b32 s12, s12, 7
    s_add_u32 m0, s100, 81920
    s_add_u32 s12, s12, s98
    buffer_load_dwordx4 v58, s[60:63], s12 offen lds
    s_add_u32 m0, s100, 82944
    s_nop 0
    buffer_load_dwordx4 v59, s[60:63], s12 offen lds
    s_add_u32 s12, s8, 5
    s_and_b32 s12, s12, 7
    s_lshl_b32 s12, s12, 16
    s_add_u32 m0, s100, 90112
    s_add_u32 s12, s12, s99
    buffer_load_dwordx4 v60, s[64:67], s12 offen lds
    s_add_u32 m0, s100, 91136
    s_nop 0
    buffer_load_dwordx4 v61, s[64:67], s12 offen lds
    s_cmp_lg_u32 s5, 4
    s_cbranch_scc1 L_nkv_15
    ds_read_b64_tr_b16 v[144:145], v18 offset:0
    ds_read_b64_tr_b16 v[146:147], v18 offset:128
    ds_read_b128 v[148:151], v19 offset:0
    ds_read_b64_tr_b16 v[152:153], v18 offset:1024
    ds_read_b64_tr_b16 v[154:155], v18 offset:1152
    ds_read_b128 v[156:159], v20 offset:0
    ds_read_b64_tr_b16 v[160:161], v18 offset:2048
    ds_read_b64_tr_b16 v[162:163], v18 offset:2176
    ds_read_b128 v[164:167], v19 offset:16384
    ds_read_b64_tr_b16 v[168:169], v18 offset:3072
    ds_read_b64_tr_b16 v[170:171], v18 offset:3200
    ds_read_b128 v[172:175], v20 offset:16384
    s_waitcnt lgkmcnt(9)
    v_mfma_f32_16x16x32_bf16 v[128:131], v[144:147], v[148:151], 0
    v_mfma_f32_16x16x32_bf16 v[132:135], v[148:151], v[144:147], 0
    s_waitcnt lgkmcnt(6)
    v_mfma_f32_16x16x32_bf16 v[128:131], v[152:155], v[156:159], v[128:131]
    v_mfma_f32_16x16x32_bf16 v[132:135], v[156:159], v[152:155], v[132:135]
    s_waitcnt lgkmcnt(3)
    v_mfma_f32_16x16x32_bf16 v[128:131], v[160:163], v[164:167], v[128:131]
    v_mfma_f32_16x16x32_bf16 v[132:135], v[164:167], v[160:163], v[132:135]
    s_waitcnt lgkmcnt(0)
    v_mfma_f32_16x16x32_bf16 v[128:131], v[168:171], v[172:175], v[128:131]
    v_mfma_f32_16x16x32_bf16 v[132:135], v[172:175], v[168:171], v[132:135]
L_nkv_15:
    s_cmp_eq_u32 s50, 0
    s_waitcnt vmcnt(9) lgkmcnt(0)
    s_cbranch_scc1 L_bg1
    s_waitcnt vmcnt(8)
L_bg1:
    s_barrier
    s_cmp_lg_u32 s5, 7
    s_cbranch_scc1 L_npa
    s_lshr_b32 s9, s4, 5
    s_lshl_b32 s9, s9, 12
    s_add_u32 s88, s9, 4849664
    buffer_load_dwordx2 v[82:83], v43, s[52:55], s88 offen sc1
L_npa:
    s_add_u32 s12, s8, 6
    s_and_b32 s12, s12, 7
    s_lshl_b32 s12, s12, 7
    s_add_u32 m0, s100, 98304
    s_add_u32 s12, s12, s98
    buffer_load_dwordx4 v58, s[60:63], s12 offen lds
    s_add_u32 m0, s100, 99328
    s_nop 0
    buffer_load_dwordx4 v59, s[60:63], s12 offen lds
    s_add_u32 s12, s8, 6
    s_and_b32 s12, s12, 7
    s_lshl_b32 s12, s12, 16
    s_add_u32 m0, s100, 106496
    s_add_u32 s12, s12, s99
    buffer_load_dwordx4 v60, s[64:67], s12 offen lds
    s_add_u32 m0, s100, 107520
    s_nop 0
    buffer_load_dwordx4 v61, s[64:67], s12 offen lds
    s_add_u32 s12, s8, 7
    s_and_b32 s12, s12, 7
    s_lshl_b32 s12, s12, 7
    s_add_u32 m0, s100, 114688
    s_add_u32 s12, s12, s98
    buffer_load_dwordx4 v58, s[60:63], s12 offen lds
    s_add_u32 m0, s100, 115712
    s_nop 0
    buffer_load_dwordx4 v59, s[60:63], s12 offen lds
    s_add_u32 s12, s8, 7
    s_and_b32 s12, s12, 7
    s_lshl_b32 s12, s12, 16
    s_add_u32 m0, s100, 122880
    s_add_u32 s12, s12, s99
    buffer_load_dwordx4 v60, s[64:67], s12 offen lds
    s_add_u32 m0, s100, 123904
    s_nop 0
    buffer_load_dwordx4 v61, s[64:67], s12 offen lds
    s_cmp_lg_u32 s5, 4
    s_cbranch_scc1 L_nkv_16
    ds_read_b64_tr_b16 v[144:145], v18 offset:4096
    ds_read_b64_tr_b16 v[146:147], v18 offset:4224
    ds_read_b128 v[148:151], v19 offset:32768
    ds_read_b64_tr_b16 v[152:153], v18 offset:5120
    ds_read_b64_tr_b16 v[154:155], v18 offset:5248
    ds_read_b128 v[156:159], v20 offset:32768
    ds_read_b64_tr_b16 v[160:161], v18 offset:6144
    ds_read_b64_tr_b16 v[162:163], v18 offset:6272
    ds_read_b128 v[164:167], v19 offset:49152
    ds_read_b64_tr_b16 v[168:169], v18 offset:7168
    ds_read_b64_tr_b16 v[170:171], v18 offset:7296
    ds_read_b128 v[172:175], v20 offset:49152
    s_waitcnt lgkmcnt(9)
    v_mfma_f32_16x16x32_bf16 v[128:131], v[144:147], v[148:151], v[128:131]
    v_mfma_f32_16x16x32_bf16 v[132:135], v[148:151], v[144:147], v[132:135]
    s_waitcnt lgkmcnt(6)
    v_mfma_f32_16x16x32_bf16 v[128:131], v[152:155], v[156:159], v[128:131]
    v_mfma_f32_16x16x32_bf16 v[132:135], v[156:159], v[152:155], v[132:135]
    s_waitcnt lgkmcnt(3)
    v_mfma_f32_16x16x32_bf16 v[128:131], v[160:163], v[164:167], v[128:131]
    v_mfma_f32_16x16x32_bf16 v[132:135], v[164:167], v[160:163], v[132:135]
    s_waitcnt lgkmcnt(0)
    v_mfma_f32_16x16x32_bf16 v[128:131], v[168:171], v[172:175], v[128:131]
    v_mfma_f32_16x16x32_bf16 v[132:135], v[172:175], v[168:171], v[132:135]
L_nkv_16:
    v_and_b32 v2, 255, v0
    v_cmp_ne_u32 vcc, 255, v2
    s_nop 1
    v_cndmask_b32 v212, 0, v212, vcc
    v_cndmask_b32 v213, 0, v213, vcc
    v_alignbit_b32 v216, v209, v208, 16
    v_alignbit_b32 v217, v210, v209, 16
    v_alignbit_b32 v218, v211, v210, 16
    v_alignbit_b32 v219, v212, v211, 16
    v_mov_b32 v220, v209
    v_mov_b32 v221, v210
    v_mov_b32 v222, v211
    v_mov_b32 v223, v212
    v_alignbit_b32 v224, v210, v209, 16
    v_alignbit_b32 v225, v211, v210, 16
    v_alignbit_b32 v226, v212, v211, 16
    v_alignbit_b32 v227, v213, v212, 16
    v_add_u32 v19, 0x10000, v19
    v_add_u32 v20, 0x10000, v20
    s_cmp_eq_u32 s5, 7
    s_waitcnt vmcnt(9)
    s_cbranch_scc1 L_bg2
    s_waitcnt vmcnt(8)
L_bg2:
    s_barrier
    s_cmp_lg_u32 s5, 4
    s_cbranch_scc1 L_nkv_17
    ds_read_b64_tr_b16 v[144:145], v18 offset:8192
    ds_read_b64_tr_b16 v[146:147], v18 offset:8320
    ds_read_b128 v[148:151], v19 offset:0
    ds_read_b64_tr_b16 v[152:153], v18 offset:9216
    ds_read_b64_tr_b16 v[154:155], v18 offset:9344
    ds_read_b128 v[156:159], v20 offset:0
    ds_read_b64_tr_b16 v[160:161], v18 offset:10240
    ds_read_b64_tr_b16 v[162:163], v18 offset:10368
    ds_read_b128 v[164:167], v19 offset:16384
    ds_read_b64_tr_b16 v[168:169], v18 offset:11264
    ds_read_b64_tr_b16 v[170:171], v18 offset:11392
    ds_read_b128 v[172:175], v20 offset:16384
    s_waitcnt lgkmcnt(9)
    v_mfma_f32_16x16x32_bf16 v[128:131], v[144:147], v[148:151], v[128:131]
    v_mfma_f32_16x16x32_bf16 v[132:135], v[148:151], v[144:147], v[132:135]
    s_waitcnt lgkmcnt(6)
    v_mfma_f32_16x16x32_bf16 v[128:131], v[152:155], v[156:159], v[128:131]
    v_mfma_f32_16x16x32_bf16 v[132:135], v[156:159], v[152:155], v[132:135]
    s_waitcnt lgkmcnt(3)
    v_mfma_f32_16x16x32_bf16 v[128:131], v[160:163], v[164:167], v[128:131]
    v_mfma_f32_16x16x32_bf16 v[132:135], v[164:167], v[160:163], v[132:135]
    s_waitcnt lgkmcnt(0)
    v_mfma_f32_16x16x32_bf16 v[128:131], v[168:171], v[172:175], v[128:131]
    v_mfma_f32_16x16x32_bf16 v[132:135], v[172:175], v[168:171], v[132:135]
L_nkv_17:
    v_mov_b64 v[4:5], 0
    v_mov_b64 v[6:7], 0
    ds_write_b128 v36, v[208:211]
    ds_write_b128 v36, v[216:219] offset:4160
    ds_write_b128 v36, v[220:223] offset:8320
    ds_write_b128 v36, v[224:227] offset:12480
    ds_write_b128 v35, v[4:7]
    s_cmp_lg_u32 s5, 7
    s_cbranch_scc1 L_nta
    s_waitcnt vmcnt(8)
    v_xor_b32 v82, s51, v82
    v_xor_b32 v83, s51, v83
    v_or_b32 v82, v82, v83
    v_cmp_ne_u32 vcc, 0, v82
    s_mov_b32 s89, 1
    s_cbranch_vccnz L_apend_18
    s_mov_b32 s89, 0
    s_lshr_b32 s9, s4, 1
    s_lshl_b32 s9, s9, 14
    s_and_b32 s10, s4, 1
    s_lshl_b32 s10, s10, 5
    s_add_u32 s9, s9, s10
    s_add_u32 s9, s9, 2097152
    s_nop 0
    buffer_load_dwordx4 v[144:147], v37, s[52:55], s9 offen offset:0 sc1
    buffer_load_dwordx4 v[148:151], v37, s[52:55], s9 offen offset:2048 sc1
    s_add_u32 s9, s9, 4096
    buffer_load_dwordx4 v[152:155], v37, s[52:55], s9 offen offset:0 sc1
    buffer_load_dwordx4 v[156:159], v37, s[52:55], s9 offen offset:2048 sc1
    s_add_u32 s9, s9, 4096
    buffer_load_dwordx4 v[160:163], v37, s[52:55], s9 offen offset:0 sc1
    buffer_load_dwordx4 v[164:167], v37, s[52:55], s9 offen offset:2048 sc1
    s_add_u32 s9, s9, 4096
    buffer_load_dwordx4 v[168:171], v37, s[52:55], s9 offen offset:0 sc1
    buffer_load_dwordx4 v[172:175], v37, s[52:55], s9 offen offset:2048 sc1
    s_add_u32 s9, s9, 4096
L_apend_18:
    s_cmp_lg_u32 s89, 0
    s_cbranch_scc1 L_nta
    s_waitcnt vmcnt(8)
    s_branch L_bg3
L_nta:
    s_waitcnt vmcnt(0)
L_bg3:
    s_barrier
    s_cmp_lg_u32 s5, 4
    s_cbranch_scc1 L_nkv_19
    ds_read_b64_tr_b16 v[144:145], v18 offset:12288
    ds_read_b64_tr_b16 v[146:147], v18 offset:12416
    ds_read_b128 v[148:151], v19 offset:32768
    ds_read_b64_tr_b16 v[152:153], v18 offset:13312
    ds_read_b64_tr_b16 v[154:155], v18 offset:13440
    ds_read_b128 v[156:159], v20 offset:32768
    ds_read_b64_tr_b16 v[160:161], v18 offset:14336
    ds_read_b64_tr_b16 v[162:163], v18 offset:14464
    ds_read_b128 v[164:167], v19 offset:49152
    ds_read_b64_tr_b16 v[168:169], v18 offset:15360
    ds_read_b64_tr_b16 v[170:171], v18 offset:15488
    ds_read_b128 v[172:175], v20 offset:49152
    s_waitcnt lgkmcnt(9)
    v_mfma_f32_16x16x32_bf16 v[128:131], v[144:147], v[148:151], v[128:131]
    v_mfma_f32_16x16x32_bf16 v[132:135], v[148:151], v[144:147], v[132:135]
    s_waitcnt lgkmcnt(6)
    v_mfma_f32_16x16x32_bf16 v[128:131], v[152:155], v[156:159], v[128:131]
    v_mfma_f32_16x16x32_bf16 v[132:135], v[156:159], v[152:155], v[132:135]
    s_waitcnt lgkmcnt(3)
    v_mfma_f32_16x16x32_bf16 v[128:131], v[160:163], v[164:167], v[128:131]
    v_mfma_f32_16x16x32_bf16 v[132:135], v[164:167], v[160:163], v[132:135]
    s_waitcnt lgkmcnt(0)
    v_mfma_f32_16x16x32_bf16 v[128:131], v[168:171], v[172:175], v[128:131]
    v_mfma_f32_16x16x32_bf16 v[132:135], v[172:175], v[168:171], v[132:135]
L_nkv_19:
    s_nop 4
    s_cmp_lg_u32 s5, 4
    s_cbranch_scc1 L_kvend_20
    v_mov_b32 v87, 0x6753c21c
    s_lshr_b32 s9, s3, 2
    s_lshl_b32 s9, s9, 11
    s_bfe_u32 s10, s7, 0x10001
    s_lshl_b32 s10, s10, 8
    s_add_u32 s9, s9, s10
    s_add_u32 s9, s9, 4719616
    s_bitcmp1_b32 s7, 0
    s_cbranch_scc1 L_kvst_22
    s_sub_u32 s9, s9, 1024
    v_mul_f32 v132, 0x3eb8aa3b, v128
    v_mul_f32 v133, 0x3eb8aa3b, v129
    v_mul_f32 v134, 0x3eb8aa3b, v130
    v_mul_f32 v135, 0x3eb8aa3b, v131
L_kvst_22:
    v_cvt_pk_bf16_f32 v148, v132, v133
    v_cvt_pk_bf16_f32 v149, v134, v135
    v_cvt_pk_bf16_f32 v150, v132, v133
    v_cvt_pk_bf16_f32 v151, v134, v135
    v_mul_f32 v4, v132, v132
    v_fmac_f32 v4, v133, v133
    v_permlane16_swap_b32 v148, v150
    v_permlane16_swap_b32 v149, v151
    s_mov_b64 exec, s[14:15]
    buffer_store_dwordx4 v[148:151], v44, s[52:55], s9 offen sc1
    s_mov_b64 exec, -1
    v_fmac_f32 v4, v134, v134
    v_fmac_f32 v4, v135, v135
    v_mov_b32 v5, v4
    s_nop 1
    v_permlane32_swap_b32 v4, v5
    s_nop 1
    v_add_f32 v4, v4, v5
    v_mov_b32 v5, v4
    s_nop 1
    v_permlane16_swap_b32 v4, v5
    s_nop 1
    v_add_f32 v86, v4, v5
    s_bitcmp1_b32 s7, 0
    s_cbranch_scc0 L_kvend_20
    v_cmp_nle_f32 vcc, v86, v87
    v_mov_b32 v5, 0x7f800000
    s_nop 0
    v_cndmask_b32 v86, 0, v5, vcc
L_kvend_20:
    s_sub_u32 s11, s5, 5
    s_cmp_ge_u32 s11, 2
    s_cbranch_scc1 L_nowt_23
    v_lshrrev_b32 v2, 4, v1
    v_and_b32 v5, 3, v1
    v_bfe_u32 v3, v1, 2, 1
    v_bfe_u32 v4, v1, 3, 1
    v_lshl_add_u32 v3, v4, 2, v3
    v_lshlrev_b32 v3, 7, v3
    v_lshl_add_u32 v3, v5, 3, v3
    v_lshl_add_u32 v3, v2, 5, v3
    s_lshl_b32 s9, s11, 5
    v_xor_b32 v3, s9, v3
    s_lshl_b32 s9, s11, 10
    s_add_u32 s9, s9, 161792
    v_add_u32 v3, s9, v3
    v_xor_b32 v4, 64, v3
    ds_read_b64_tr_b16 v[6:7], v3
    ds_read_b64_tr_b16 v[8:9], v4 offset:256
    v_lshrrev_b32 v3, 2, v1
    v_lshlrev_b32 v3, 4, v3
    v_lshl_add_u32 v3, v5, 8, v3
    v_add_u32 v3, s9, v3
    v_add_u32 v4, s9, v15
    v_and_b32 v5, 15, v1
    v_lshlrev_b32 v5, 4, v5
    v_lshl_add_u32 v2, v2, 11, v5
    s_waitcnt lgkmcnt(0)
    ds_write_b128 v3, v[6:9]
    ds_read_b128 v[6:9], v4
    s_lshr_b32 s9, s6, 2
    s_lshl_b32 s9, s9, 16
    s_lshl_b32 s10, s7, 13
    s_add_u32 s9, s9, s10
    s_and_b32 s10, s6, 3
    s_lshl_b32 s10, s10, 9
    s_add_u32 s9, s9, s10
    s_lshl_b32 s10, s11, 8
    s_add_u32 s9, s9, s10
    s_add_u32 s9, s9, 4194304
    s_waitcnt lgkmcnt(0)
    buffer_store_dwordx4 v[6:9], v2, s[52:55], s9 offen sc1
L_nowt_23:
L_gjoin:
    s_cmp_eq_u32 s50, 0
    s_cbranch_scc1 L_p1done
    s_add_u32 s3, s3, 1
    s_waitcnt vmcnt(0) lgkmcnt(0)
    s_barrier
    v_and_b32 v2, 255, v0
    v_lshlrev_b32 v2, 1, v2
    s_lshl_b32 s9, s4, 9
    v_add_u32 v9, s9, v2
    s_cmp_lt_u32 s3, 256
    s_cbranch_scc1 L_phase1
    s_mov_b32 s89, 1
L_p1done:
    v_add_u32 v85, 0xffff, v85
    v_add_u32 v86, 0xffff, v86
    v_lshlrev_b32 v2, 2, v0
    v_and_b32 v85, 0xffff0000, v85
    v_lshrrev_b32 v86, 16, v86
    v_or_b32 v85, v85, v86
    ds_write_b32 v2, v85 offset:12288
    s_cmp_lg_u32 s5, 7
    s_cbranch_scc1 L_b4
    s_cmp_lg_u32 s89, 0
    s_cbranch_scc1 L_upend
    s_waitcnt vmcnt(0)
L_uok:
    ds_write_b128 v38, v[144:147]
    ds_write_b128 v38, v[148:151] offset:640
    ds_write_b128 v38, v[152:155] offset:1280
    ds_write_b128 v38, v[156:159] offset:1920
    ds_write_b128 v38, v[160:163] offset:2560
    ds_write_b128 v38, v[164:167] offset:3200
    ds_write_b128 v38, v[168:171] offset:3840
    ds_write_b128 v38, v[172:175] offset:4480
L_b4:
    s_waitcnt lgkmcnt(0)
    s_barrier
    s_cmp_ge_u32 s5, 4
    s_cbranch_scc1 L_nocv
    ds_read_b64 v[192:193], v40 offset:2048
    ds_read_b64 v[194:195], v40 offset:2056
    ds_read_b128 v[200:203], v39 offset:0
    ds_read_b128 v[204:207], v39 offset:2560
    ds_read_b64 v[196:197], v40 offset:0
    ds_read_b64 v[198:199], v40 offset:8
    ds_read_b64 v[208:209], v40 offset:2112
    ds_read_b64 v[210:211], v40 offset:2120
    ds_read_b128 v[216:219], v39 offset:80
    ds_read_b128 v[220:223], v39 offset:2640
    ds_read_b64 v[212:213], v40 offset:64
    ds_read_b64 v[214:215], v40 offset:72
    .p2align 3
    s_waitcnt lgkmcnt(6)
    v_mfma_f32_32x32x16_bf16 v[128:143], v[192:195], v[200:203], 0
    ds_read_b64 v[224:225], v40 offset:2176
    ds_read_b64 v[226:227], v40 offset:2184
    v_mfma_f32_32x32x16_bf16 v[144:159], v[192:195], v[204:207], 0
    ds_read_b128 v[232:235], v39 offset:160
    ds_read_b128 v[236:239], v39 offset:2720
    v_mfma_f32_32x32x16_bf16 v[144:159], v[196:199], v[200:203], v[144:159]
    ds_read_b64 v[228:229], v40 offset:128
    ds_read_b64 v[230:231], v40 offset:136
    s_waitcnt lgkmcnt(6)
    v_mfma_f32_32x32x16_bf16 v[128:143], v[208:211], v[216:219], v[128:143]
    ds_read_b64 v[192:193], v40 offset:2240
    ds_read_b64 v[194:195], v40 offset:2248
    v_mfma_f32_32x32x16_bf16 v[144:159], v[208:211], v[220:223], v[144:159]
    ds_read_b128 v[200:203], v39 offset:240
    ds_read_b128 v[204:207], v39 offset:2800
    v_mfma_f32_32x32x16_bf16 v[144:159], v[212:215], v[216:219], v[144:159]
    ds_read_b64 v[196:197], v40 offset:192
    ds_read_b64 v[198:199], v40 offset:200
    s_waitcnt lgkmcnt(6)
    v_mfma_f32_32x32x16_bf16 v[128:143], v[224:227], v[232:235], v[128:143]
    ds_read_b64 v[208:209], v40 offset:2304
    ds_read_b64 v[210:211], v40 offset:2312
    v_mfma_f32_32x32x16_bf16 v[144:159], v[224:227], v[236:239], v[144:159]
    ds_read_b128 v[216:219], v39 offset:320
    ds_read_b128 v[220:223], v39 offset:2880
    v_mfma_f32_32x32x16_bf16 v[144:159], v[228:231], v[232:235], v[144:159]
    ds_read_b64 v[212:213], v40 offset:256
    ds_read_b64 v[214:215], v40 offset:264
    s_waitcnt lgkmcnt(6)
    v_mfma_f32_32x32x16_bf16 v[128:143], v[192:195], v[200:203], v[128:143]
    ds_read_b64 v[224:225], v40 offset:2368
    ds_read_b64 v[226:227], v40 offset:2376
    v_mfma_f32_32x32x16_bf16 v[144:159], v[192:195], v[204:207], v[144:159]
    ds_read_b128 v[232:235], v39 offset:400
    ds_read_b128 v[236:239], v39 offset:2960
    v_mfma_f32_32x32x16_bf16 v[144:159], v[196:199], v[200:203], v[144:159]
    ds_read_b64 v[228:229], v40 offset:320
    ds_read_b64 v[230:231], v40 offset:328
    s_waitcnt lgkmcnt(6)
    v_mfma_f32_32x32x16_bf16 v[128:143], v[208:211], v[216:219], v[128:143]
    ds_read_b64 v[192:193], v40 offset:2432
    ds_read_b64 v[194:195], v40 offset:2440
    v_mfma_f32_32x32x16_bf16 v[144:159], v[208:211], v[220:223], v[144:159]
    ds_read_b128 v[200:203], v39 offset:480
    ds_read_b128 v[204:207], v39 offset:3040
    v_mfma_f32_32x32x16_bf16 v[144:159], v[212:215], v[216:219], v[144:159]
    ds_read_b64 v[196:197], v40 offset:384
    ds_read_b64 v[198:199], v40 offset:392
    v_mov_b32 v2, 8192
    v_mov_b32 v3, 1
    v_mov_b32 v4, s91
    s_waitcnt vmcnt(0)
    s_mov_b64 exec, 1
    ds_or_b32 v2, v4
    ds_add_u32 v2, v3 offset:4
    s_mov_b64 exec, -1
    s_waitcnt lgkmcnt(8)
    v_mfma_f32_32x32x16_bf16 v[128:143], v[224:227], v[232:235], v[128:143]
    ds_read_b64 v[208:209], v40 offset:2496
    ds_read_b64 v[210:211], v40 offset:2504
    v_mfma_f32_32x32x16_bf16 v[144:159], v[224:227], v[236:239], v[144:159]
    ds_read_b128 v[216:219], v39 offset:560
    ds_read_b128 v[220:223], v39 offset:3120
    v_mfma_f32_32x32x16_bf16 v[144:159], v[228:231], v[232:235], v[144:159]
    ds_read_b64 v[212:213], v40 offset:448
    ds_read_b64 v[214:215], v40 offset:456
    s_waitcnt lgkmcnt(8)
    v_mfma_f32_32x32x16_bf16 v[128:143], v[192:195], v[200:203], v[128:143]
    ds_read_b64 v[224:225], v40 offset:2560
    ds_read_b64 v[226:227], v40 offset:2568
    v_mfma_f32_32x32x16_bf16 v[144:159], v[192:195], v[204:207], v[144:159]
    ds_read_b128 v[232:235], v39 offset:640
    ds_read_b128 v[236:239], v39 offset:3200
    v_mfma_f32_32x32x16_bf16 v[144:159], v[196:199], v[200:203], v[144:159]
    ds_read_b64 v[228:229], v40 offset:512
    ds_read_b64 v[230:231], v40 offset:520
    s_waitcnt lgkmcnt(6)
    v_mfma_f32_32x32x16_bf16 v[128:143], v[208:211], v[216:219], v[128:143]
    ds_read_b64 v[192:193], v40 offset:2624
    ds_read_b64 v[194:195], v40 offset:2632
    v_mfma_f32_32x32x16_bf16 v[144:159], v[208:211], v[220:223], v[144:159]
    ds_read_b128 v[200:203], v39 offset:720
    ds_read_b128 v[204:207], v39 offset:3280
    v_mfma_f32_32x32x16_bf16 v[144:159], v[212:215], v[216:219], v[144:159]
    ds_read_b64 v[196:197], v40 offset:576
    ds_read_b64 v[198:199], v40 offset:584
    s_waitcnt lgkmcnt(6)
    v_mfma_f32_32x32x16_bf16 v[128:143], v[224:227], v[232:235], v[128:143]
    ds_read_b64 v[208:209], v40 offset:2688
    ds_read_b64 v[210:211], v40 offset:2696
    v_mfma_f32_32x32x16_bf16 v[144:159], v[224:227], v[236:239], v[144:159]
    ds_read_b128 v[216:219], v39 offset:800
    ds_read_b128 v[220:223], v39 offset:3360
    v_mfma_f32_32x32x16_bf16 v[144:159], v[228:231], v[232:235], v[144:159]
    ds_read_b64 v[212:213], v40 offset:640
    ds_read_b64 v[214:215], v40 offset:648
    s_waitcnt lgkmcnt(6)
    v_mfma_f32_32x32x16_bf16 v[128:143], v[192:195], v[200:203], v[128:143]
    ds_read_b64 v[224:225], v40 offset:2752
    ds_read_b64 v[226:227], v40 offset:2760
    v_mfma_f32_32x32x16_bf16 v[144:159], v[192:195], v[204:207], v[144:159]
    ds_read_b128 v[232:235], v39 offset:880
    ds_read_b128 v[236:239], v39 offset:3440
    v_mfma_f32_32x32x16_bf16 v[144:159], v[196:199], v[200:203], v[144:159]
    ds_read_b64 v[228:229], v40 offset:704
    ds_read_b64 v[230:231], v40 offset:712
    s_waitcnt lgkmcnt(6)
    v_mfma_f32_32x32x16_bf16 v[128:143], v[208:211], v[216:219], v[128:143]
    ds_read_b64 v[192:193], v40 offset:2816
    ds_read_b64 v[194:195], v40 offset:2824
    v_mfma_f32_32x32x16_bf16 v[144:159], v[208:211], v[220:223], v[144:159]
    ds_read_b128 v[200:203], v39 offset:960
    ds_read_b128 v[204:207], v39 offset:3520
    v_mfma_f32_32x32x16_bf16 v[144:159], v[212:215], v[216:219], v[144:159]
    ds_read_b64 v[196:197], v40 offset:768
    ds_read_b64 v[198:199], v40 offset:776
    s_waitcnt lgkmcnt(6)
    v_mfma_f32_32x32x16_bf16 v[128:143], v[224:227], v[232:235], v[128:143]
    ds_read_b64 v[208:209], v40 offset:2880
    ds_read_b64 v[210:211], v40 offset:2888
    v_mfma_f32_32x32x16_bf16 v[144:159], v[224:227], v[236:239], v[144:159]
    ds_read_b128 v[216:219], v39 offset:1040
    ds_read_b128 v[220:223], v39 offset:3600
    v_mfma_f32_32x32x16_bf16 v[144:159], v[228:231], v[232:235], v[144:159]
    ds_read_b64 v[212:213], v40 offset:832
    ds_read_b64 v[214:215], v40 offset:840
    s_waitcnt lgkmcnt(6)
    v_mfma_f32_32x32x16_bf16 v[128:143], v[192:195], v[200:203], v[128:143]
    ds_read_b64 v[224:225], v40 offset:2944
    ds_read_b64 v[226:227], v40 offset:2952
    v_mfma_f32_32x32x16_bf16 v[144:159], v[192:195], v[204:207], v[144:159]
    ds_read_b128 v[232:235], v39 offset:1120
    ds_read_b128 v[236:239], v39 offset:3680
    v_mfma_f32_32x32x16_bf16 v[144:159], v[196:199], v[200:203], v[144:159]
    ds_read_b64 v[228:229], v40 offset:896
    ds_read_b64 v[230:231], v40 offset:904
    s_waitcnt lgkmcnt(6)
    v_mfma_f32_32x32x16_bf16 v[128:143], v[208:211], v[216:219], v[128:143]
    ds_read_b64 v[192:193], v40 offset:3008
    ds_read_b64 v[194:195], v40 offset:3016
    v_mfma_f32_32x32x16_bf16 v[144:159], v[208:211], v[220:223], v[144:159]
    ds_read_b128 v[200:203], v39 offset:1200
    ds_read_b128 v[204:207], v39 offset:3760
    v_mfma_f32_32x32x16_bf16 v[144:159], v[212:215], v[216:219], v[144:159]
    ds_read_b64 v[196:197], v40 offset:960
    ds_read_b64 v[198:199], v40 offset:968
    s_waitcnt lgkmcnt(6)
    v_mfma_f32_32x32x16_bf16 v[128:143], v[224:227], v[232:235], v[128:143]
    ds_read_b64 v[208:209], v40 offset:3072
    ds_read_b64 v[210:211], v40 offset:3080
    v_mfma_f32_32x32x16_bf16 v[144:159], v[224:227], v[236:239], v[144:159]
    ds_read_b128 v[216:219], v39 offset:1280
    ds_read_b128 v[220:223], v39 offset:3840
    v_mfma_f32_32x32x16_bf16 v[144:159], v[228:231], v[232:235], v[144:159]
    ds_read_b64 v[212:213], v40 offset:1024
    ds_read_b64 v[214:215], v40 offset:1032
    s_waitcnt lgkmcnt(6)
    v_mfma_f32_32x32x16_bf16 v[128:143], v[192:195], v[200:203], v[128:143]
    ds_read_b64 v[224:225], v40 offset:3136
    ds_read_b64 v[226:227], v40 offset:3144
    v_mfma_f32_32x32x16_bf16 v[144:159], v[192:195], v[204:207], v[144:159]
    ds_read_b128 v[232:235], v39 offset:1360
    ds_read_b128 v[236:239], v39 offset:3920
    v_mfma_f32_32x32x16_bf16 v[144:159], v[196:199], v[200:203], v[144:159]
    ds_read_b64 v[228:229], v40 offset:1088
    ds_read_b64 v[230:231], v40 offset:1096
    s_waitcnt lgkmcnt(6)
    v_mfma_f32_32x32x16_bf16 v[128:143], v[208:211], v[216:219], v[128:143]
    ds_read_b64 v[192:193], v40 offset:3200
    ds_read_b64 v[194:195], v40 offset:3208
    v_mfma_f32_32x32x16_bf16 v[144:159], v[208:211], v[220:223], v[144:159]
    ds_read_b128 v[200:203], v39 offset:1440
    ds_read_b128 v[204:207], v39 offset:4000
    v_mfma_f32_32x32x16_bf16 v[144:159], v[212:215], v[216:219], v[144:159]
    ds_read_b64 v[196:197], v40 offset:1152
    ds_read_b64 v[198:199], v40 offset:1160
    s_waitcnt lgkmcnt(6)
    v_mfma_f32_32x32x16_bf16 v[128:143], v[224:227], v[232:235], v[128:143]
    ds_read_b64 v[208:209], v40 offset:3264
    ds_read_b64 v[210:211], v40 offset:3272
    v_mfma_f32_32x32x16_bf16 v[144:159], v[224:227], v[236:239], v[144:159]
    ds_read_b128 v[216:219], v39 offset:1520
    ds_read_b128 v[220:223], v39 offset:4080
    v_mfma_f32_32x32x16_bf16 v[144:159], v[228:231], v[232:235], v[144:159]
    ds_read_b64 v[212:213], v40 offset:1216
    ds_read_b64 v[214:215], v40 offset:1224
    s_waitcnt lgkmcnt(6)
    v_mfma_f32_32x32x16_bf16 v[128:143], v[192:195], v[200:203], v[128:143]
    ds_read_b64 v[224:225], v40 offset:3328
    ds_read_b64 v[226:227], v40 offset:3336
    v_mfma_f32_32x32x16_bf16 v[144:159], v[192:195], v[204:207], v[144:159]
    ds_read_b128 v[232:235], v39 offset:1600
    ds_read_b128 v[236:239], v39 offset:4160
    v_mfma_f32_32x32x16_bf16 v[144:159], v[196:199], v[200:203], v[144:159]
    ds_read_b64 v[228:229], v40 offset:1280
    ds_read_b64 v[230:231], v40 offset:1288
    s_waitcnt lgkmcnt(6)
    v_mfma_f32_32x32x16_bf16 v[128:143], v[208:211], v[216:219], v[128:143]
    ds_read_b64 v[192:193], v40 offset:3392
    ds_read_b64 v[194:195], v40 offset:3400
    v_mfma_f32_32x32x16_bf16 v[144:159], v[208:211], v[220:223], v[144:159]
    ds_read_b128 v[200:203], v39 offset:1680
    ds_read_b128 v[204:207], v39 offset:4240
    v_mfma_f32_32x32x16_bf16 v[144:159], v[212:215], v[216:219], v[144:159]
    ds_read_b64 v[196:197], v40 offset:1344
    ds_read_b64 v[198:199], v40 offset:1352
    s_waitcnt lgkmcnt(6)
    v_mfma_f32_32x32x16_bf16 v[128:143], v[224:227], v[232:235], v[128:143]
    ds_read_b64 v[208:209], v40 offset:3456
    ds_read_b64 v[210:211], v40 offset:3464
    v_mfma_f32_32x32x16_bf16 v[144:159], v[224:227], v[236:239], v[144:159]
    ds_read_b128 v[216:219], v39 offset:1760
    ds_read_b128 v[220:223], v39 offset:4320
    v_mfma_f32_32x32x16_bf16 v[144:159], v[228:231], v[232:235], v[144:159]
    ds_read_b64 v[212:213], v40 offset:1408
    ds_read_b64 v[214:215], v40 offset:1416
    s_waitcnt lgkmcnt(6)
    v_mfma_f32_32x32x16_bf16 v[128:143], v[192:195], v[200:203], v[128:143]
    ds_read_b64 v[224:225], v40 offset:3520
    ds_read_b64 v[226:227], v40 offset:3528
    v_mfma_f32_32x32x16_bf16 v[144:159], v[192:195], v[204:207], v[144:159]
    ds_read_b128 v[232:235], v39 offset:1840
    ds_read_b128 v[236:239], v39 offset:4400
    v_mfma_f32_32x32x16_bf16 v[144:159], v[196:199], v[200:203], v[144:159]
    ds_read_b64 v[228:229], v40 offset:1472
    ds_read_b64 v[230:231], v40 offset:1480
    s_waitcnt lgkmcnt(6)
    v_mfma_f32_32x32x16_bf16 v[128:143], v[208:211], v[216:219], v[128:143]
    ds_read_b64 v[192:193], v40 offset:3584
    ds_read_b64 v[194:195], v40 offset:3592
    v_mfma_f32_32x32x16_bf16 v[144:159], v[208:211], v[220:223], v[144:159]
    ds_read_b128 v[200:203], v39 offset:1920
    ds_read_b128 v[204:207], v39 offset:4480
    v_mfma_f32_32x32x16_bf16 v[144:159], v[212:215], v[216:219], v[144:159]
    ds_read_b64 v[196:197], v40 offset:1536
    ds_read_b64 v[198:199], v40 offset:1544
    s_waitcnt lgkmcnt(6)
    v_mfma_f32_32x32x16_bf16 v[128:143], v[224:227], v[232:235], v[128:143]
    ds_read_b64 v[208:209], v40 offset:3648
    ds_read_b64 v[210:211], v40 offset:3656
    v_mfma_f32_32x32x16_bf16 v[144:159], v[224:227], v[236:239], v[144:159]
    ds_read_b128 v[216:219], v39 offset:2000
    ds_read_b128 v[220:223], v39 offset:4560
    v_mfma_f32_32x32x16_bf16 v[144:159], v[228:231], v[232:235], v[144:159]
    ds_read_b64 v[212:213], v40 offset:1600
    ds_read_b64 v[214:215], v40 offset:1608
    s_waitcnt lgkmcnt(6)
    v_mfma_f32_32x32x16_bf16 v[128:143], v[192:195], v[200:203], v[128:143]
    ds_read_b64 v[224:225], v40 offset:3712
    ds_read_b64 v[226:227], v40 offset:3720
    v_mfma_f32_32x32x16_bf16 v[144:159], v[192:195], v[204:207], v[144:159]
    ds_read_b128 v[232:235], v39 offset:2080
    ds_read_b128 v[236:239], v39 offset:4640
    v_mfma_f32_32x32x16_bf16 v[144:159], v[196:199], v[200:203], v[144:159]
    ds_read_b64 v[228:229], v40 offset:1664
    ds_read_b64 v[230:231], v40 offset:1672
    s_waitcnt lgkmcnt(6)
    v_mfma_f32_32x32x16_bf16 v[128:143], v[208:211], v[216:219], v[128:143]
    ds_read_b64 v[192:193], v40 offset:3776
    ds_read_b64 v[194:195], v40 offset:3784
    v_mfma_f32_32x32x16_bf16 v[144:159], v[208:211], v[220:223], v[144:159]
    ds_read_b128 v[200:203], v39 offset:2160
    ds_read_b128 v[204:207], v39 offset:4720
    v_mfma_f32_32x32x16_bf16 v[144:159], v[212:215], v[216:219], v[144:159]
    ds_read_b64 v[196:197], v40 offset:1728
    ds_read_b64 v[198:199], v40 offset:1736
    s_waitcnt lgkmcnt(6)
    v_mfma_f32_32x32x16_bf16 v[128:143], v[224:227], v[232:235], v[128:143]
    ds_read_b64 v[208:209], v40 offset:3840
    ds_read_b64 v[210:211], v40 offset:3848
    v_mfma_f32_32x32x16_bf16 v[144:159], v[224:227], v[236:239], v[144:159]
    ds_read_b128 v[216:219], v39 offset:2240
    ds_read_b128 v[220:223], v39 offset:4800
    v_mfma_f32_32x32x16_bf16 v[144:159], v[228:231], v[232:235], v[144:159]
    ds_read_b64 v[212:213], v40 offset:1792
    ds_read_b64 v[214:215], v40 offset:1800
    s_waitcnt lgkmcnt(6)
    v_mfma_f32_32x32x16_bf16 v[128:143], v[192:195], v[200:203], v[128:143]
    ds_read_b64 v[224:225], v40 offset:3904
    ds_read_b64 v[226:227], v40 offset:3912
    v_mfma_f32_32x32x16_bf16 v[144:159], v[192:195], v[204:207], v[144:159]
    ds_read_b128 v[232:235], v39 offset:2320
    ds_read_b128 v[236:239], v39 offset:4880
    v_mfma_f32_32x32x16_bf16 v[144:159], v[196:199], v[200:203], v[144:159]
    ds_read_b64 v[228:229], v40 offset:1856
    ds_read_b64 v[230:231], v40 offset:1864
    s_waitcnt lgkmcnt(6)
    v_mfma_f32_32x32x16_bf16 v[128:143], v[208:211], v[216:219], v[128:143]
    ds_read_b64 v[192:193], v40 offset:3968
    ds_read_b64 v[194:195], v40 offset:3976
    v_mfma_f32_32x32x16_bf16 v[144:159], v[208:211], v[220:223], v[144:159]
    ds_read_b128 v[200:203], v39 offset:2400
    ds_read_b128 v[204:207], v39 offset:4960
    v_mfma_f32_32x32x16_bf16 v[144:159], v[212:215], v[216:219], v[144:159]
    ds_read_b64 v[196:197], v40 offset:1920
    ds_read_b64 v[198:199], v40 offset:1928
    s_waitcnt lgkmcnt(6)
    v_mfma_f32_32x32x16_bf16 v[128:143], v[224:227], v[232:235], v[128:143]
    ds_read_b64 v[208:209], v40 offset:4032
    ds_read_b64 v[210:211], v40 offset:4040
    v_mfma_f32_32x32x16_bf16 v[144:159], v[224:227], v[236:239], v[144:159]
    ds_read_b128 v[216:219], v39 offset:2480
    ds_read_b128 v[220:223], v39 offset:5040
    v_mfma_f32_32x32x16_bf16 v[144:159], v[228:231], v[232:235], v[144:159]
    ds_read_b64 v[212:213], v40 offset:1984
    ds_read_b64 v[214:215], v40 offset:1992
    s_waitcnt lgkmcnt(6)
    v_mfma_f32_32x32x16_bf16 v[128:143], v[192:195], v[200:203], v[128:143]
    v_mfma_f32_32x32x16_bf16 v[144:159], v[192:195], v[204:207], v[144:159]
    v_mfma_f32_32x32x16_bf16 v[144:159], v[196:199], v[200:203], v[144:159]
    s_waitcnt lgkmcnt(0)
    v_mfma_f32_32x32x16_bf16 v[128:143], v[208:211], v[216:219], v[128:143]
    v_mfma_f32_32x32x16_bf16 v[144:159], v[208:211], v[220:223], v[144:159]
    v_mfma_f32_32x32x16_bf16 v[144:159], v[212:215], v[216:219], v[144:159]
    v_xor_b32 v2, 64, v41
    v_xor_b32 v3, 128, v41
    v_xor_b32 v4, 192, v41
    s_nop 6
    ds_write_b128 v41, v[128:131] offset:0
    ds_write_b128 v2, v[132:135] offset:1024
    ds_write_b128 v3, v[136:139] offset:2048
    ds_write_b128 v4, v[140:143] offset:3072
    s_nop 0
    ds_write_b128 v41, v[144:147] offset:4096
    ds_write_b128 v2, v[148:151] offset:5120
    ds_write_b128 v3, v[152:155] offset:6144
    ds_write_b128 v4, v[156:159] offset:7168
    s_branch L_cvdone
L_nocv:
    s_setprio 3
    v_mov_b32 v2, 8192
    v_mov_b32 v3, 1
    v_mov_b32 v4, s91
    s_waitcnt vmcnt(0)
    s_mov_b64 exec, 1
    ds_or_b32 v2, v4
    ds_add_u32 v2, v3 offset:4
    s_mov_b64 exec, -1
    v_mov_b32 v4, 8192
    s_cmp_eq_u32 s5, 7
    s_cbranch_scc1 L_ackl_26
L_bwait_28:
    s_sleep 1
    ds_read_b32 v5, v4 offset:8
    s_waitcnt lgkmcnt(0)
    v_cmp_eq_u32 vcc, 0, v5
    s_cbranch_vccnz L_bwait_28
    s_branch L_bstage_29
L_ackl_26:
    v_lshlrev_b32 v2, 2, v1
    ds_read2st64_b32 v[128:129], v2 offset0:48 offset1:49
    ds_read2st64_b32 v[130:131], v2 offset0:50 offset1:51
    ds_read2st64_b32 v[132:133], v2 offset0:52 offset1:53
    ds_read2st64_b32 v[134:135], v2 offset0:54 offset1:55
    s_mov_b32 s13, 0
    s_or_b32 s91, s50, 2
    s_cmp_lg_u32 s50, 0
    s_waitcnt lgkmcnt(0)
    s_cbranch_scc1 L_bgo_27
    v_pk_max_u16 v128, v128, v129
    v_pk_max_u16 v130, v130, v131
    v_pk_max_u16 v132, v132, v133
    v_pk_max_u16 v134, v134, v135
    v_pk_max_u16 v128, v128, v130
    v_pk_max_u16 v132, v132, v134
    v_pk_max_u16 v3, v128, v132
    s_nop 1
    v_mov_b32_dpp v5, v3 row_ror:8 row_mask:0xf bank_mask:0xf
    v_pk_max_u16 v3, v3, v5
    s_nop 1
    v_mov_b32_dpp v5, v3 row_ror:4 row_mask:0xf bank_mask:0xf
    v_pk_max_u16 v3, v3, v5
    s_nop 1
    v_mov_b32_dpp v5, v3 row_ror:2 row_mask:0xf bank_mask:0xf
    v_pk_max_u16 v3, v3, v5
    s_nop 1
    v_mov_b32_dpp v5, v3 row_ror:1 row_mask:0xf bank_mask:0xf
    v_pk_max_u16 v3, v3, v5
    v_mov_b32 v5, v3
    s_nop 1
    v_permlane16_swap_b32 v5, v3
    s_nop 1
    v_pk_max_u16 v3, v3, v5
    v_mov_b32 v5, v3
    s_nop 1
    v_permlane32_swap_b32 v5, v3
    s_nop 1
    v_pk_max_u16 v3, v3, v5
    v_mov_b32 v2, s51
    s_lshl_b32 s9, s2, 3
    s_add_u32 s9, s9, 4882432
L_ackc_31:
    ds_read_b32 v5, v4 offset:4
    s_waitcnt lgkmcnt(0)
    v_cmp_ne_u32 vcc, 8, v5
    s_cbranch_vccnz L_ackc_31
    v_mov_b32 v5, 0
    s_mov_b64 exec, 1
    buffer_store_dwordx2 v[2:3], v5, s[52:55], s9 offen sc1
    s_mov_b64 exec, -1
    s_mov_b32 s9, 4882432
    s_sleep 24
L_bspin_25:
    buffer_load_dwordx4 v[128:131], v15, s[52:55], s9 offen sc1
    buffer_load_dwordx4 v[132:135], v15, s[52:55], s9 offen offset:1024 sc1
    s_add_u32 s13, s13, 1
    s_waitcnt vmcnt(0)
    v_xor_b32 v2, s51, v128
    v_xor_b32 v5, s51, v130
    v_xor_b32 v6, s51, v132
    v_xor_b32 v7, s51, v134
    v_or3_b32 v2, v2, v5, v6
    v_or_b32 v2, v2, v7
    v_cmp_ne_u32 vcc, 0, v2
    s_cbranch_vccz L_bok_24
    s_mov_b64 exec, vcc
    s_sleep 4
    s_cmp_lt_u32 s13, 20000
    s_cbranch_scc1 L_bspin_25
    s_cmp_gt_u32 s13, 20000
    s_cbranch_scc1 L_bgv_30
    s_mov_b64 s[80:81], exec
    s_mov_b64 exec, 1
    v_mov_b32 v2, s51
    v_mov_b32 v5, 4884608
    buffer_store_dword v2, v5, s[52:55], 0 offen sc1
    s_waitcnt vmcnt(0)
    s_mov_b64 exec, s[80:81]
    s_branch L_bspin_25
L_bgv_30:
    s_or_b32 s91, s91, 13
L_bok_24:
    s_mov_b64 exec, -1
    v_mov_b32 v6, 4884608
    buffer_load_dword v6, v6, s[52:55], 0 offen sc1
L_bgo_27:
    v_mov_b32 v5, 1
    ds_write_b32 v4, v5 offset:8
L_bstage_29:
    s_lshr_b32 s11, s100, 1
    s_lshl_b32 s9, s4, 13
    s_add_u32 m0, s11, 0
    s_add_u32 s9, s9, s11
    buffer_load_dwordx4 v15, s[52:55], s9 offen sc1 lds
    s_bfe_u32 s9, s5, 0x10001
    s_lshl_b32 s9, s9, 16
    s_and_b32 s10, s5, 1
    s_lshl_b32 s10, s10, 10
    s_add_u32 s9, s9, s10
    s_add_u32 s9, s9, 4718592
    s_add_u32 m0, s11, 65536
    s_nop 0
    buffer_load_dwordx4 v15, s[52:55], s9 offen sc1 lds
    s_add_u32 s9, s9, 2048
    s_add_u32 m0, s11, 69632
    s_nop 0
    buffer_load_dwordx4 v15, s[52:55], s9 offen sc1 lds
    s_add_u32 s9, s9, 2048
    s_add_u32 m0, s11, 73728
    s_nop 0
    buffer_load_dwordx4 v15, s[52:55], s9 offen sc1 lds
    s_add_u32 s9, s9, 2048
    s_add_u32 m0, s11, 77824
    s_nop 0
    buffer_load_dwordx4 v15, s[52:55], s9 offen sc1 lds
    s_add_u32 s9, s9, 2048
    s_add_u32 m0, s11, 81920
    s_nop 0
    buffer_load_dwordx4 v15, s[52:55], s9 offen sc1 lds
    s_add_u32 s9, s9, 2048
    s_add_u32 m0, s11, 86016
    s_nop 0
    buffer_load_dwordx4 v15, s[52:55], s9 offen sc1 lds
    s_add_u32 s9, s9, 2048
    s_add_u32 m0, s11, 90112
    s_nop 0
    buffer_load_dwordx4 v15, s[52:55], s9 offen sc1 lds
    s_add_u32 s9, s9, 2048
    s_add_u32 m0, s11, 94208
    s_nop 0
    buffer_load_dwordx4 v15, s[52:55], s9 offen sc1 lds
    s_add_u32 s9, s9, 2048
    s_cmp_lg_u32 s5, 7
    s_cbranch_scc1 L_gsk2_33
    s_cmp_lg_u32 s50, 0
    s_cbranch_scc1 L_gsk_32
    v_pk_max_u16 v3, v129, v131
    v_pk_max_u16 v5, v133, v135
    v_pk_max_u16 v3, v3, v5
    s_nop 1
    v_mov_b32_dpp v5, v3 row_ror:8 row_mask:0xf bank_mask:0xf
    v_pk_max_u16 v3, v3, v5
    s_nop 1
    v_mov_b32_dpp v5, v3 row_ror:4 row_mask:0xf bank_mask:0xf
    v_pk_max_u16 v3, v3, v5
    s_nop 1
    v_mov_b32_dpp v5, v3 row_ror:2 row_mask:0xf bank_mask:0xf
    v_pk_max_u16 v3, v3, v5
    s_nop 1
    v_mov_b32_dpp v5, v3 row_ror:1 row_mask:0xf bank_mask:0xf
    v_pk_max_u16 v3, v3, v5
    v_mov_b32 v5, v3
    s_nop 1
    v_permlane16_swap_b32 v5, v3
    s_nop 1
    v_pk_max_u16 v3, v3, v5
    v_mov_b32 v5, v3
    s_nop 1
    v_permlane32_swap_b32 v5, v3
    s_nop 1
    v_pk_max_u16 v3, v3, v5
    v_and_b32 v5, 0xffff0000, v3
    v_lshlrev_b32 v3, 16, v3
    v_mul_f32 v3, v3, v5
    v_cmp_ge_f32 vcc, 0x44d8589e, v3
    s_cbranch_vccz L_gsk3_34
    s_and_b32 s91, s91, 13
L_gsk3_34:
    s_waitcnt vmcnt(9)
    v_cmp_eq_u32 vcc, s51, v6
    s_cbranch_vccz L_gsk_32
    s_or_b32 s91, s91, 4
L_gsk_32:
    v_mov_b32 v3, s91
    s_mov_b64 exec, 1
    ds_or_b32 v4, v3
    s_mov_b64 exec, -1
L_gsk2_33:
    s_waitcnt vmcnt(0)
    s_setprio 0
L_cvdone:
    s_waitcnt lgkmcnt(0)
    s_barrier
    v_mov_b32 v6, 8192
    ds_read_b32 v6, v6
    ds_read_b128 v[104:107], v45
    ds_read_b128 v[80:83], v14
    s_lshl_b32 s9, s4, 13
    s_lshr_b32 s10, s100, 1
    s_add_u32 s9, s9, s10
    s_add_u32 s9, s9, 4096
    buffer_load_dwordx4 v[108:111], v15, s[52:55], s9 offen sc1
    s_mov_b64 exec, s[14:15]
    ds_read_b128 v[88:91], v14 offset:1024
    ds_read_b128 v[92:95], v14 offset:1280
    s_mov_b64 exec, -1
    ds_read_b128 v[128:131], v249
    ds_read_b128 v[132:135], v249 offset:512
    ds_read_b128 v[136:139], v249 offset:8192
    ds_read_b128 v[140:143], v249 offset:8704
    ds_read_b128 v[144:147], v250
    s_lshl_b32 s9, s90, 4
    s_sub_u32 s9, 16, s9
    s_lshl_b32 s86, s85, s9
    s_and_b32 s86, s86, 0xffff0000
    s_mov_b32 s87, s86
    s_waitcnt lgkmcnt(7)
    v_readfirstlane_b32 s101, v6
    s_and_b32 s9, s101, 3
    s_cbranch_scc1 L_slow
L_slow_done:
    v_mfma_f32_32x32x16_bf16 v[16:31], v[80:83], v[104:107], v[64:79]
    ds_read_b128 v[80:83], v14 offset:4096
    s_lshl_b32 s9, s90, 11
    s_bfe_u32 s10, s5, 0x10001
    s_lshl_b32 s10, s10, 16
    s_add_u32 s9, s9, s10
    s_and_b32 s10, s5, 1
    s_lshl_b32 s10, s10, 10
    s_add_u32 s9, s9, s10
    s_add_u32 s89, s9, 4734976
    s_lshl_b32 s88, s5, 13
    s_add_u32 s88, s88, 4194304
    s_nop 0
    v_exp_f32 v16, v16
    v_exp_f32 v17, v17
    s_mov_b32 vcc_lo, s90
    s_mov_b32 vcc_hi, 0
    .p2align 3
    s_mov_b64 exec, s[14:15]
    ds_read_b128 v[96:99], v14 offset:5120
    ds_read_b128 v[100:103], v14 offset:5376
    s_mov_b64 exec, -1
    v_exp_f32 v18, v18
    v_exp_f32 v19, v19
    v_exp_f32 v20, v20
    s_waitcnt lgkmcnt(2)
    v_mfma_f32_32x32x16_bf16 v[32:47], v[80:83], v[104:107], v[64:79]
    ds_read_b128 v[80:83], v14 offset:8192
    s_setprio 2
    v_exp_f32 v21, v21
    v_exp_f32 v22, v22
    v_exp_f32 v23, v23
    v_exp_f32 v24, v24
    v_pk_add_f32 v[128:129], v[128:129], v[136:137]
    v_pk_add_f32 v[130:131], v[130:131], v[138:139]
    v_pk_add_f32 v[132:133], v[132:133], v[140:141]
    v_pk_add_f32 v[134:135], v[134:135], v[142:143]
    v_exp_f32 v25, v25
    v_exp_f32 v26, v26
    v_smfmac_f32_32x32x32_bf16 v[48:63], v[88:91], v[16:23], v12
    v_exp_f32 v27, v27
    v_exp_f32 v28, v28
    v_exp_f32 v29, v29
    s_add_u32 m0, s92, 98304
    s_nop 0
    buffer_load_dwordx4 v15, s[52:55], s89 offen sc1 lds
    s_add_u32 s89, s89, 4096
    v_lshlrev_b32 v136, 16, v144
    v_and_b32 v137, 0xffff0000, v144
    v_lshlrev_b32 v138, 16, v145
    v_and_b32 v139, 0xffff0000, v145
    v_lshlrev_b32 v140, 16, v146
    v_and_b32 v141, 0xffff0000, v146
    v_lshlrev_b32 v142, 16, v147
    v_and_b32 v143, 0xffff0000, v147
    v_exp_f32 v30, v30
    v_exp_f32 v31, v31
    s_setprio 0
    v_exp_f32 v32, v32
    v_exp_f32 v33, v33
    v_smfmac_f32_32x32x32_bf16 v[48:63], v[92:95], v[24:31], v12
    s_mov_b64 exec, s[14:15]
    ds_read_b128 v[88:91], v14 offset:9216
    ds_read_b128 v[92:95], v14 offset:9472
    s_mov_b64 exec, -1
    v_exp_f32 v34, v34
    v_exp_f32 v35, v35
    v_exp_f32 v36, v36
    s_waitcnt lgkmcnt(2)
    v_mfma_f32_32x32x16_bf16 v[16:31], v[80:83], v[104:107], v[64:79]
    ds_read_b128 v[80:83], v14 offset:12288
    s_setprio 2
    v_exp_f32 v37, v37
    v_exp_f32 v38, v38
    v_exp_f32 v39, v39
    v_exp_f32 v40, v40
    v_pk_fma_f32 v[128:129], v[136:137], s[86:87], v[128:129]
    v_pk_fma_f32 v[130:131], v[138:139], s[86:87], v[130:131]
    v_pk_fma_f32 v[132:133], v[140:141], s[86:87], v[132:133]
    v_pk_fma_f32 v[134:135], v[142:143], s[86:87], v[134:135]
    v_cvt_pk_bf16_f32 v144, v128, v129
    v_cvt_pk_bf16_f32 v145, v130, v131
    v_cvt_pk_bf16_f32 v146, v132, v133
    v_cvt_pk_bf16_f32 v147, v134, v135
    v_exp_f32 v41, v41
    v_exp_f32 v42, v42
    v_smfmac_f32_32x32x32_bf16 v[48:63], v[96:99], v[32:39], v12
    v_exp_f32 v43, v43
    v_exp_f32 v44, v44
    v_exp_f32 v45, v45
    s_add_u32 m0, s92, 106496
    s_nop 0
    buffer_load_dwordx4 v15, s[52:55], s89 offen sc1 lds
    s_add_u32 s89, s89, 4096
    v_exp_f32 v46, v46
    v_exp_f32 v47, v47
    s_lshl_b32 s9, s4, 13
    s_add_u32 s9, s9, s92
    s_add_u32 s9, s9, 5242880
    buffer_store_dwordx4 v[144:147], v15, s[52:55], s9 offen sc1
    s_bitcmp1_b32 s101, 2
    s_cbranch_scc1 L_scatter
L_scatter_done:
    s_setprio 0
    v_exp_f32 v16, v16
    v_exp_f32 v17, v17
    v_smfmac_f32_32x32x32_bf16 v[48:63], v[100:103], v[40:47], v12
    s_mov_b64 exec, s[14:15]
    ds_read_b128 v[96:99], v14 offset:13312
    ds_read_b128 v[100:103], v14 offset:13568
    s_mov_b64 exec, -1
    v_exp_f32 v18, v18
    v_exp_f32 v19, v19
    v_exp_f32 v20, v20
    s_waitcnt lgkmcnt(2)
    v_mfma_f32_32x32x16_bf16 v[32:47], v[80:83], v[104:107], v[64:79]
    ds_read_b128 v[80:83], v14 offset:16384
    s_setprio 2
    v_exp_f32 v21, v21
    v_exp_f32 v22, v22
    v_exp_f32 v23, v23
    v_exp_f32 v24, v24
    v_exp_f32 v25, v25
    v_exp_f32 v26, v26
    v_smfmac_f32_32x32x32_bf16 v[48:63], v[88:91], v[16:23], v12
    v_exp_f32 v27, v27
    v_exp_f32 v28, v28
    v_exp_f32 v29, v29
    s_add_u32 m0, s92, 114688
    s_nop 0
    buffer_load_dwordx4 v15, s[52:55], s89 offen sc1 lds
    s_add_u32 s89, s89, 4096
    v_exp_f32 v30, v30
    v_exp_f32 v31, v31
    s_setprio 0
    v_exp_f32 v32, v32
    v_exp_f32 v33, v33
    v_smfmac_f32_32x32x32_bf16 v[48:63], v[92:95], v[24:31], v12
    s_mov_b64 exec, s[14:15]
    ds_read_b128 v[88:91], v14 offset:17408
    ds_read_b128 v[92:95], v14 offset:17664
    s_mov_b64 exec, -1
    v_exp_f32 v34, v34
    v_exp_f32 v35, v35
    v_exp_f32 v36, v36
    s_waitcnt lgkmcnt(2)
    v_mfma_f32_32x32x16_bf16 v[16:31], v[80:83], v[104:107], v[64:79]
    ds_read_b128 v[80:83], v14 offset:20480
    s_setprio 2
    v_exp_f32 v37, v37
    v_exp_f32 v38, v38
    v_exp_f32 v39, v39
    v_exp_f32 v40, v40
    v_exp_f32 v41, v41
    v_exp_f32 v42, v42
    v_smfmac_f32_32x32x32_bf16 v[48:63], v[96:99], v[32:39], v12
    v_exp_f32 v43, v43
    v_exp_f32 v44, v44
    v_exp_f32 v45, v45
    s_add_u32 m0, s92, 122880
    s_nop 0
    buffer_load_dwordx4 v15, s[52:55], s89 offen sc1 lds
    s_add_u32 s89, s89, 4096
    buffer_load_dwordx4 v[128:131], v15, s[52:55], s88 offen offset:0 sc1
    v_exp_f32 v46, v46
    v_exp_f32 v47, v47
    s_setprio 0
    v_exp_f32 v16, v16
    v_exp_f32 v17, v17
    v_smfmac_f32_32x32x32_bf16 v[48:63], v[100:103], v[40:47], v12
    s_mov_b64 exec, s[14:15]
    ds_read_b128 v[96:99], v14 offset:21504
    ds_read_b128 v[100:103], v14 offset:21760
    s_mov_b64 exec, -1
    v_exp_f32 v18, v18
    v_exp_f32 v19, v19
    v_exp_f32 v20, v20
    s_waitcnt lgkmcnt(2)
    v_mfma_f32_32x32x16_bf16 v[32:47], v[80:83], v[104:107], v[64:79]
    ds_read_b128 v[80:83], v14 offset:24576
    s_setprio 2
    v_exp_f32 v21, v21
    v_exp_f32 v22, v22
    v_exp_f32 v23, v23
    v_exp_f32 v24, v24
    v_exp_f32 v25, v25
    v_exp_f32 v26, v26
    v_smfmac_f32_32x32x32_bf16 v[48:63], v[88:91], v[16:23], v12
    v_exp_f32 v27, v27
    v_exp_f32 v28, v28
    v_exp_f32 v29, v29
    buffer_load_dwordx4 v[132:135], v15, s[52:55], s88 offen offset:1024 sc1
    v_exp_f32 v30, v30
    v_exp_f32 v31, v31
    s_setprio 0
    v_exp_f32 v32, v32
    v_exp_f32 v33, v33
    v_smfmac_f32_32x32x32_bf16 v[48:63], v[92:95], v[24:31], v12
    s_mov_b64 exec, s[14:15]
    ds_read_b128 v[88:91], v14 offset:25600
    ds_read_b128 v[92:95], v14 offset:25856
    s_mov_b64 exec, -1
    v_exp_f32 v34, v34
    v_exp_f32 v35, v35
    v_exp_f32 v36, v36
    s_waitcnt lgkmcnt(2)
    s_waitcnt vmcnt(3)
    s_barrier
    v_mov_b32 v2, 157696
    v_mov_b64 v[4:5], 0
    v_mov_b64 v[6:7], 0
    s_mov_b64 exec, 1
    ds_write_b128 v2, v[4:7]
    s_mov_b64 exec, -1
    v_mfma_f32_32x32x16_bf16 v[16:31], v[80:83], v[104:107], v[64:79]
    ds_read_b128 v[80:83], v14 offset:28672
    s_setprio 2
    v_exp_f32 v37, v37
    v_exp_f32 v38, v38
    v_exp_f32 v39, v39
    v_exp_f32 v40, v40
    v_exp_f32 v41, v41
    v_exp_f32 v42, v42
    v_smfmac_f32_32x32x32_bf16 v[48:63], v[96:99], v[32:39], v12
    v_exp_f32 v43, v43
    v_exp_f32 v44, v44
    v_exp_f32 v45, v45
    s_add_u32 m0, s92, 0
    s_nop 0
    buffer_load_dwordx4 v15, s[52:55], s89 offen sc1 lds
    s_add_u32 s89, s89, 4096
    buffer_load_dwordx4 v[136:139], v15, s[52:55], s88 offen offset:2048 sc1
    v_exp_f32 v46, v46
    v_exp_f32 v47, v47
    s_setprio 0
    v_exp_f32 v16, v16
    v_exp_f32 v17, v17
    v_smfmac_f32_32x32x32_bf16 v[48:63], v[100:103], v[40:47], v12
    s_mov_b64 exec, s[14:15]
    ds_read_b128 v[96:99], v14 offset:29696
    ds_read_b128 v[100:103], v14 offset:29952
    s_mov_b64 exec, -1
    v_exp_f32 v18, v18
    v_exp_f32 v19, v19
    v_exp_f32 v20, v20
    s_waitcnt lgkmcnt(2)
    v_mfma_f32_32x32x16_bf16 v[32:47], v[80:83], v[104:107], v[64:79]
    ds_read_b128 v[80:83], v14 offset:32768
    s_setprio 2
    v_exp_f32 v21, v21
    v_exp_f32 v22, v22
    v_exp_f32 v23, v23
    v_exp_f32 v24, v24
    v_exp_f32 v25, v25
    v_exp_f32 v26, v26
    v_smfmac_f32_32x32x32_bf16 v[48:63], v[88:91], v[16:23], v12
    v_exp_f32 v27, v27
    v_exp_f32 v28, v28
    v_exp_f32 v29, v29
    s_add_u32 m0, s92, 8192
    s_nop 0
    buffer_load_dwordx4 v15, s[52:55], s89 offen sc1 lds
    s_add_u32 s89, s89, 4096
    buffer_load_dwordx4 v[140:143], v15, s[52:55], s88 offen offset:3072 sc1
    s_add_u32 s88, s88, 4096
    v_exp_f32 v30, v30
    v_exp_f32 v31, v31
    s_setprio 0
    v_exp_f32 v32, v32
    v_exp_f32 v33, v33
    v_smfmac_f32_32x32x32_bf16 v[48:63], v[92:95], v[24:31], v12
    s_mov_b64 exec, s[14:15]
    ds_read_b128 v[88:91], v14 offset:33792
    ds_read_b128 v[92:95], v14 offset:34048
    s_mov_b64 exec, -1
    v_exp_f32 v34, v34
    v_exp_f32 v35, v35
    v_exp_f32 v36, v36
    s_waitcnt lgkmcnt(2)
    v_mfma_f32_32x32x16_bf16 v[16:31], v[80:83], v[104:107], v[64:79]
    ds_read_b128 v[80:83], v14 offset:36864
    s_setprio 2
    v_exp_f32 v37, v37
    v_exp_f32 v38, v38
    v_exp_f32 v39, v39
    v_exp_f32 v40, v40
    v_exp_f32 v41, v41
    v_exp_f32 v42, v42
    v_smfmac_f32_32x32x32_bf16 v[48:63], v[96:99], v[32:39], v12
    v_exp_f32 v43, v43
    v_exp_f32 v44, v44
    v_exp_f32 v45, v45
    s_add_u32 m0, s92, 16384
    s_nop 0
    buffer_load_dwordx4 v15, s[52:55], s89 offen sc1 lds
    s_add_u32 s89, s89, 4096
    buffer_load_dwordx4 v[144:147], v15, s[52:55], s88 offen offset:0 sc1
    v_exp_f32 v46, v46
    v_exp_f32 v47, v47
    s_setprio 0
    v_exp_f32 v16, v16
    v_exp_f32 v17, v17
    v_smfmac_f32_32x32x32_bf16 v[48:63], v[100:103], v[40:47], v12
    s_mov_b64 exec, s[14:15]
    ds_read_b128 v[96:99], v14 offset:37888
    ds_read_b128 v[100:103], v14 offset:38144
    s_mov_b64 exec, -1
    v_exp_f32 v18, v18
    v_exp_f32 v19, v19
    v_exp_f32 v20, v20
    s_waitcnt lgkmcnt(2)
    v_mfma_f32_32x32x16_bf16 v[32:47], v[80:83], v[104:107], v[64:79]
    ds_read_b128 v[80:83], v14 offset:40960
    s_setprio 2
    v_exp_f32 v21, v21
    v_exp_f32 v22, v22
    v_exp_f32 v23, v23
    v_exp_f32 v24, v24
    v_exp_f32 v25, v25
    v_exp_f32 v26, v26
    v_smfmac_f32_32x32x32_bf16 v[48:63], v[88:91], v[16:23], v12
    v_exp_f32 v27, v27
    v_exp_f32 v28, v28
    v_exp_f32 v29, v29
    s_add_u32 m0, s92, 24576
    s_nop 0
    buffer_load_dwordx4 v15, s[52:55], s89 offen sc1 lds
    s_add_u32 s89, s89, 4096
    buffer_load_dwordx4 v[148:151], v15, s[52:55], s88 offen offset:1024 sc1
    v_exp_f32 v30, v30
    v_exp_f32 v31, v31
    s_setprio 0
    v_exp_f32 v32, v32
    v_exp_f32 v33, v33
    v_smfmac_f32_32x32x32_bf16 v[48:63], v[92:95], v[24:31], v12
    s_mov_b64 exec, s[14:15]
    ds_read_b128 v[88:91], v14 offset:41984
    ds_read_b128 v[92:95], v14 offset:42240
    s_mov_b64 exec, -1
    v_exp_f32 v34, v34
    v_exp_f32 v35, v35
    v_exp_f32 v36, v36
    s_waitcnt lgkmcnt(2)
    v_mfma_f32_32x32x16_bf16 v[16:31], v[80:83], v[104:107], v[64:79]
    ds_read_b128 v[80:83], v14 offset:45056
    s_setprio 2
    v_exp_f32 v37, v37
    v_exp_f32 v38, v38
    v_exp_f32 v39, v39
    v_exp_f32 v40, v40
    v_exp_f32 v41, v41
    v_exp_f32 v42, v42
    v_smfmac_f32_32x32x32_bf16 v[48:63], v[96:99], v[32:39], v12
    v_exp_f32 v43, v43
    v_exp_f32 v44, v44
    v_exp_f32 v45, v45
    s_add_u32 m0, s92, 32768
    s_nop 0
    buffer_load_dwordx4 v15, s[52:55], s89 offen sc1 lds
    s_add_u32 s89, s89, 4096
    buffer_load_dwordx4 v[152:155], v15, s[52:55], s88 offen offset:2048 sc1
    v_exp_f32 v46, v46
    v_exp_f32 v47, v47
    s_setprio 0
    v_exp_f32 v16, v16
    v_exp_f32 v17, v17
    v_smfmac_f32_32x32x32_bf16 v[48:63], v[100:103], v[40:47], v12
    s_mov_b64 exec, s[14:15]
    ds_read_b128 v[96:99], v14 offset:46080
    ds_read_b128 v[100:103], v14 offset:46336
    s_mov_b64 exec, -1
    v_exp_f32 v18, v18
    v_exp_f32 v19, v19
    v_exp_f32 v20, v20
    s_waitcnt lgkmcnt(2)
    v_mfma_f32_32x32x16_bf16 v[32:47], v[80:83], v[104:107], v[64:79]
    ds_read_b128 v[80:83], v14 offset:49152
    s_setprio 2
    v_exp_f32 v21, v21
    v_exp_f32 v22, v22
    v_exp_f32 v23, v23
    v_exp_f32 v24, v24
    v_exp_f32 v25, v25
    v_exp_f32 v26, v26
    v_smfmac_f32_32x32x32_bf16 v[48:63], v[88:91], v[16:23], v12
    v_exp_f32 v27, v27
    v_exp_f32 v28, v28
    v_exp_f32 v29, v29
    s_add_u32 m0, s92, 40960
    s_nop 0
    buffer_load_dwordx4 v15, s[52:55], s89 offen sc1 lds
    s_add_u32 s89, s89, 4096
    buffer_load_dwordx4 v[156:159], v15, s[52:55], s88 offen offset:3072 sc1
    s_add_u32 s88, s88, 61440
    v_exp_f32 v30, v30
    v_exp_f32 v31, v31
    s_setprio 0
    v_exp_f32 v32, v32
    v_exp_f32 v33, v33
    v_smfmac_f32_32x32x32_bf16 v[48:63], v[92:95], v[24:31], v12
    s_mov_b64 exec, s[14:15]
    ds_read_b128 v[88:91], v14 offset:50176
    ds_read_b128 v[92:95], v14 offset:50432
    s_mov_b64 exec, -1
    v_exp_f32 v34, v34
    v_exp_f32 v35, v35
    v_exp_f32 v36, v36
    s_waitcnt lgkmcnt(2)
    s_waitcnt vmcnt(5)
    s_barrier
    s_cmp_lg_u32 s5, 0
    s_cbranch_scc1 L_nofc
    s_lshl_b32 s9, s4, 7
    s_add_u32 s9, s9, 4885504
    v_mov_b32 v2, 0
    v_mov_b32 v3, s51
    s_mov_b64 exec, 1
    buffer_store_dword v3, v2, s[52:55], s9 offen sc1
    s_mov_b64 exec, -1
L_nofc:
    v_mfma_f32_32x32x16_bf16 v[16:31], v[80:83], v[104:107], v[64:79]
    ds_read_b128 v[80:83], v14 offset:53248
    s_setprio 2
    v_exp_f32 v37, v37
    v_exp_f32 v38, v38
    v_exp_f32 v39, v39
    v_exp_f32 v40, v40
    v_exp_f32 v41, v41
    v_exp_f32 v42, v42
    v_smfmac_f32_32x32x32_bf16 v[48:63], v[96:99], v[32:39], v12
    v_exp_f32 v43, v43
    v_exp_f32 v44, v44
    v_exp_f32 v45, v45
    s_add_u32 m0, s92, 49152
    s_nop 0
    buffer_load_dwordx4 v15, s[52:55], s89 offen sc1 lds
    s_add_u32 s89, s89, 4096
    buffer_load_dwordx4 v[160:163], v15, s[52:55], s88 offen offset:0 sc1
    v_exp_f32 v46, v46
    v_exp_f32 v47, v47
    s_setprio 0
    v_exp_f32 v16, v16
    v_exp_f32 v17, v17
    v_smfmac_f32_32x32x32_bf16 v[48:63], v[100:103], v[40:47], v12
    s_mov_b64 exec, s[14:15]
    ds_read_b128 v[96:99], v14 offset:54272
    ds_read_b128 v[100:103], v14 offset:54528
    s_mov_b64 exec, -1
    v_exp_f32 v18, v18
    v_exp_f32 v19, v19
    v_exp_f32 v20, v20
    s_waitcnt lgkmcnt(2)
    v_mfma_f32_32x32x16_bf16 v[32:47], v[80:83], v[104:107], v[64:79]
    ds_read_b128 v[80:83], v14 offset:57344
    s_setprio 2
    v_exp_f32 v21, v21
    v_exp_f32 v22, v22
    v_exp_f32 v23, v23
    v_exp_f32 v24, v24
    v_exp_f32 v25, v25
    v_exp_f32 v26, v26
    v_smfmac_f32_32x32x32_bf16 v[48:63], v[88:91], v[16:23], v12
    v_exp_f32 v27, v27
    v_exp_f32 v28, v28
    v_exp_f32 v29, v29
    s_add_u32 m0, s92, 57344
    s_nop 0
    buffer_load_dwordx4 v15, s[52:55], s89 offen sc1 lds
    s_add_u32 s89, s89, 4096
    buffer_load_dwordx4 v[164:167], v15, s[52:55], s88 offen offset:1024 sc1
    v_exp_f32 v30, v30
    v_exp_f32 v31, v31
    s_setprio 0
    v_exp_f32 v32, v32
    v_exp_f32 v33, v33
    v_smfmac_f32_32x32x32_bf16 v[48:63], v[92:95], v[24:31], v12
    s_mov_b64 exec, s[14:15]
    ds_read_b128 v[88:91], v14 offset:58368
    ds_read_b128 v[92:95], v14 offset:58624
    s_mov_b64 exec, -1
    v_exp_f32 v34, v34
    v_exp_f32 v35, v35
    v_exp_f32 v36, v36
    s_waitcnt lgkmcnt(2)
    v_mfma_f32_32x32x16_bf16 v[16:31], v[80:83], v[104:107], v[64:79]
    ds_read_b128 v[80:83], v14 offset:61440
    s_setprio 2
    v_exp_f32 v37, v37
    v_exp_f32 v38, v38
    v_exp_f32 v39, v39
    v_exp_f32 v40, v40
    v_exp_f32 v41, v41
    v_exp_f32 v42, v42
    v_smfmac_f32_32x32x32_bf16 v[48:63], v[96:99], v[32:39], v12
    v_exp_f32 v43, v43
    v_exp_f32 v44, v44
    v_exp_f32 v45, v45
    buffer_load_dwordx4 v[168:171], v15, s[52:55], s88 offen offset:2048 sc1
    v_exp_f32 v46, v46
    v_exp_f32 v47, v47
    s_setprio 0
    v_exp_f32 v16, v16
    v_exp_f32 v17, v17
    v_smfmac_f32_32x32x32_bf16 v[48:63], v[100:103], v[40:47], v12
    s_mov_b64 exec, s[14:15]
    ds_read_b128 v[96:99], v14 offset:62464
    ds_read_b128 v[100:103], v14 offset:62720
    s_mov_b64 exec, -1
    v_exp_f32 v18, v18
    v_exp_f32 v19, v19
    v_exp_f32 v20, v20
    s_waitcnt lgkmcnt(2)
    v_mfma_f32_32x32x16_bf16 v[32:47], v[80:83], v[104:107], v[64:79]
    v_xor_b32 v0, 0x10000, v14
    ds_read_b128 v[80:83], v0 offset:0
    s_setprio 2
    v_exp_f32 v21, v21
    v_exp_f32 v22, v22
    v_exp_f32 v23, v23
    v_exp_f32 v24, v24
    v_exp_f32 v25, v25
    v_exp_f32 v26, v26
    v_smfmac_f32_32x32x32_bf16 v[48:63], v[88:91], v[16:23], v12
    v_exp_f32 v27, v27
    v_exp_f32 v28, v28
    v_exp_f32 v29, v29
    buffer_load_dwordx4 v[172:175], v15, s[52:55], s88 offen offset:3072 sc1
    s_add_u32 s88, s88, 4096
    v_exp_f32 v30, v30
    v_exp_f32 v31, v31
    s_setprio 0
    v_exp_f32 v32, v32
    v_exp_f32 v33, v33
    v_smfmac_f32_32x32x32_bf16 v[48:63], v[92:95], v[24:31], v12
    v_mov_b32 v14, v0
    s_mov_b64 exec, s[14:15]
    ds_read_b128 v[88:91], v14 offset:1024
    ds_read_b128 v[92:95], v14 offset:1280
    s_mov_b64 exec, -1
    v_exp_f32 v34, v34
    v_exp_f32 v35, v35
    v_exp_f32 v36, v36
    s_waitcnt lgkmcnt(2)
    v_mfma_f32_32x32x16_bf16 v[16:31], v[80:83], v[104:107], v[64:79]
    ds_read_b128 v[80:83], v14 offset:4096
    s_setprio 2
    v_exp_f32 v37, v37
    v_exp_f32 v38, v38
    v_exp_f32 v39, v39
    v_exp_f32 v40, v40
    v_exp_f32 v41, v41
    v_exp_f32 v42, v42
    v_smfmac_f32_32x32x32_bf16 v[48:63], v[96:99], v[32:39], v12
    v_exp_f32 v43, v43
    v_exp_f32 v44, v44
    v_exp_f32 v45, v45
    buffer_load_dwordx4 v[176:179], v15, s[52:55], s88 offen offset:0 sc1
    v_exp_f32 v46, v46
    v_exp_f32 v47, v47
    s_setprio 0
    v_exp_f32 v16, v16
    v_exp_f32 v17, v17
    v_smfmac_f32_32x32x32_bf16 v[48:63], v[100:103], v[40:47], v12
    s_mov_b64 exec, s[14:15]
    ds_read_b128 v[96:99], v14 offset:5120
    ds_read_b128 v[100:103], v14 offset:5376
    s_mov_b64 exec, -1
    v_exp_f32 v18, v18
    v_exp_f32 v19, v19
    v_exp_f32 v20, v20
    s_waitcnt lgkmcnt(2)
    v_mfma_f32_32x32x16_bf16 v[32:47], v[80:83], v[104:107], v[64:79]
    ds_read_b128 v[80:83], v14 offset:8192
    s_setprio 2
    v_exp_f32 v21, v21
    v_exp_f32 v22, v22
    v_exp_f32 v23, v23
    v_exp_f32 v24, v24
    s_lshr_b32 s9, s4, 5
    s_lshl_b32 s9, s9, 12
    s_add_u32 s93, s9, 4885504
    s_cmp_lg_u32 s5, 1
    s_cbranch_scc1 L_noci
    buffer_load_dword v8, v255, s[52:55], s93 offen sc1
L_noci:
    v_exp_f32 v25, v25
    v_exp_f32 v26, v26
    v_smfmac_f32_32x32x32_bf16 v[48:63], v[88:91], v[16:23], v12
    v_exp_f32 v27, v27
    v_exp_f32 v28, v28
    v_exp_f32 v29, v29
    buffer_load_dwordx4 v[180:183], v15, s[52:55], s88 offen offset:1024 sc1
    v_exp_f32 v30, v30
    v_exp_f32 v31, v31
    s_setprio 0
    v_exp_f32 v32, v32
    v_exp_f32 v33, v33
    v_smfmac_f32_32x32x32_bf16 v[48:63], v[92:95], v[24:31], v12
    s_mov_b64 exec, s[14:15]
    ds_read_b128 v[88:91], v14 offset:9216
    ds_read_b128 v[92:95], v14 offset:9472
    s_mov_b64 exec, -1
    v_exp_f32 v34, v34
    v_exp_f32 v35, v35
    v_exp_f32 v36, v36
    s_waitcnt lgkmcnt(2)
    v_mfma_f32_32x32x16_bf16 v[16:31], v[80:83], v[104:107], v[64:79]
    ds_read_b128 v[80:83], v14 offset:12288
    s_setprio 2
    v_exp_f32 v37, v37
    v_exp_f32 v38, v38
    v_exp_f32 v39, v39
    v_exp_f32 v40, v40
    v_exp_f32 v41, v41
    v_exp_f32 v42, v42
    v_smfmac_f32_32x32x32_bf16 v[48:63], v[96:99], v[32:39], v12
    v_exp_f32 v43, v43
    v_exp_f32 v44, v44
    v_exp_f32 v45, v45
    buffer_load_dwordx4 v[184:187], v15, s[52:55], s88 offen offset:2048 sc1
    v_exp_f32 v46, v46
    v_exp_f32 v47, v47
    s_setprio 0
    v_exp_f32 v16, v16
    v_exp_f32 v17, v17
    v_smfmac_f32_32x32x32_bf16 v[48:63], v[100:103], v[40:47], v12
    s_mov_b64 exec, s[14:15]
    ds_read_b128 v[96:99], v14 offset:13312
    ds_read_b128 v[100:103], v14 offset:13568
    s_mov_b64 exec, -1
    v_exp_f32 v18, v18
    v_exp_f32 v19, v19
    v_exp_f32 v20, v20
    s_waitcnt lgkmcnt(2)
    v_mfma_f32_32x32x16_bf16 v[32:47], v[80:83], v[104:107], v[64:79]
    ds_read_b128 v[80:83], v14 offset:16384
    s_setprio 2
    v_exp_f32 v21, v21
    v_exp_f32 v22, v22
    v_exp_f32 v23, v23
    v_exp_f32 v24, v24
    v_exp_f32 v25, v25
    v_exp_f32 v26, v26
    v_smfmac_f32_32x32x32_bf16 v[48:63], v[88:91], v[16:23], v12
    v_exp_f32 v27, v27
    v_exp_f32 v28, v28
    v_exp_f32 v29, v29
    buffer_load_dwordx4 v[188:191], v15, s[52:55], s88 offen offset:3072 sc1
    s_add_u32 s88, s88, 61440
    v_exp_f32 v30, v30
    v_exp_f32 v31, v31
    s_setprio 0
    v_exp_f32 v32, v32
    v_exp_f32 v33, v33
    v_smfmac_f32_32x32x32_bf16 v[48:63], v[92:95], v[24:31], v12
    s_mov_b64 exec, s[14:15]
    ds_read_b128 v[88:91], v14 offset:17408
    ds_read_b128 v[92:95], v14 offset:17664
    s_mov_b64 exec, -1
    v_exp_f32 v34, v34
    v_exp_f32 v35, v35
    v_exp_f32 v36, v36
    s_waitcnt lgkmcnt(2)
    v_mfma_f32_32x32x16_bf16 v[16:31], v[80:83], v[104:107], v[64:79]
    ds_read_b128 v[80:83], v14 offset:20480
    s_setprio 2
    v_exp_f32 v37, v37
    v_exp_f32 v38, v38
    v_exp_f32 v39, v39
    v_exp_f32 v40, v40
    s_waitcnt vmcnt(2)
    s_and_b32 s9, s101, 8
    s_add_u32 s9, s9, s5
    s_cmp_lg_u32 s9, 1
    s_cbranch_scc1 L_cok
    v_cmp_ne_u32 s[80:81], s51, v8
    s_cmp_lg_u64 s[80:81], 0
    s_cbranch_scc1 L_cspin
L_cok:
    v_mov_b32 v2, 157696
    v_mov_b32 v3, 1
    s_mov_b64 exec, 1
    ds_add_u32 v2, v3 offset:0
    s_mov_b64 exec, -1
    v_exp_f32 v41, v41
    v_exp_f32 v42, v42
    v_smfmac_f32_32x32x32_bf16 v[48:63], v[96:99], v[32:39], v12
    v_exp_f32 v43, v43
    v_exp_f32 v44, v44
    v_exp_f32 v45, v45
    buffer_load_dwordx4 v[192:195], v15, s[52:55], s88 offen offset:0 sc1
    v_exp_f32 v46, v46
    v_exp_f32 v47, v47
    s_setprio 0
    v_exp_f32 v16, v16
    v_exp_f32 v17, v17
    v_smfmac_f32_32x32x32_bf16 v[48:63], v[100:103], v[40:47], v12
    s_mov_b64 exec, s[14:15]
    ds_read_b128 v[96:99], v14 offset:21504
    ds_read_b128 v[100:103], v14 offset:21760
    s_mov_b64 exec, -1
    v_exp_f32 v18, v18
    v_exp_f32 v19, v19
    v_exp_f32 v20, v20
    s_waitcnt lgkmcnt(3)
    s_or_b32 s9, s2, s5
    s_or_b32 s9, s9, s50
    s_cmp_lg_u32 s9, 0
    s_cbranch_scc1 L_noep0
    v_mov_b32 v2, 0
    v_mov_b32 v3, s51
    s_mov_b32 s9, 4884480
    s_mov_b64 exec, 1
    buffer_store_dword v3, v2, s[52:55], s9 offen sc1
    s_mov_b64 exec, -1
L_noep0:
    v_mfma_f32_32x32x16_bf16 v[32:47], v[80:83], v[104:107], v[64:79]
    ds_read_b128 v[80:83], v14 offset:24576
    s_setprio 2
    v_exp_f32 v21, v21
    v_exp_f32 v22, v22
    v_exp_f32 v23, v23
    v_exp_f32 v24, v24
    v_exp_f32 v25, v25
    v_exp_f32 v26, v26
    v_smfmac_f32_32x32x32_bf16 v[48:63], v[88:91], v[16:23], v12
    v_exp_f32 v27, v27
    v_exp_f32 v28, v28
    v_exp_f32 v29, v29
    buffer_load_dwordx4 v[196:199], v15, s[52:55], s88 offen offset:1024 sc1
    v_exp_f32 v30, v30
    v_exp_f32 v31, v31
    v_mov_b32 v9, 157696
    ds_read_b32 v9, v9 offset:0
    s_setprio 0
    v_exp_f32 v32, v32
    v_exp_f32 v33, v33
    v_smfmac_f32_32x32x32_bf16 v[48:63], v[92:95], v[24:31], v12
    s_mov_b64 exec, s[14:15]
    ds_read_b128 v[88:91], v14 offset:25600
    ds_read_b128 v[92:95], v14 offset:25856
    s_mov_b64 exec, -1
    v_exp_f32 v34, v34
    v_exp_f32 v35, v35
    v_exp_f32 v36, v36
    s_waitcnt lgkmcnt(3)
    s_waitcnt lgkmcnt(2)
    v_readfirstlane_b32 s12, v9
    s_cmp_lg_u32 s12, 8
    s_cbranch_scc1 L_sbs_35
L_sbo_36:
    s_lshr_b32 s9, s4, 5
    s_lshl_b32 s9, s9, 18
    s_and_b32 s10, s4, 31
    s_lshl_b32 s10, s10, 7
    s_add_u32 s9, s9, s10
    s_add_u32 m0, s92, 149504
    s_add_u32 s9, s9, 5242880
    buffer_load_dwordx4 v251, s[52:55], s9 offen sc1 lds
    v_mfma_f32_32x32x16_bf16 v[16:31], v[80:83], v[104:107], v[64:79]
    ds_read_b128 v[80:83], v14 offset:28672
    s_setprio 2
    v_exp_f32 v37, v37
    v_exp_f32 v38, v38
    v_exp_f32 v39, v39
    v_exp_f32 v40, v40
    v_exp_f32 v41, v41
    v_exp_f32 v42, v42
    v_smfmac_f32_32x32x32_bf16 v[48:63], v[96:99], v[32:39], v12
    v_exp_f32 v43, v43
    v_exp_f32 v44, v44
    v_exp_f32 v45, v45
    buffer_load_dwordx4 v[200:203], v15, s[52:55], s88 offen offset:2048 sc1
    v_exp_f32 v46, v46
    v_exp_f32 v47, v47
    s_setprio 0
    v_exp_f32 v16, v16
    v_exp_f32 v17, v17
    v_smfmac_f32_32x32x32_bf16 v[48:63], v[100:103], v[40:47], v12
    s_mov_b64 exec, s[14:15]
    ds_read_b128 v[96:99], v14 offset:29696
    ds_read_b128 v[100:103], v14 offset:29952
    s_mov_b64 exec, -1
    v_exp_f32 v18, v18
    v_exp_f32 v19, v19
    v_exp_f32 v20, v20
    s_waitcnt lgkmcnt(2)
    v_mfma_f32_32x32x16_bf16 v[32:47], v[80:83], v[104:107], v[64:79]
    ds_read_b128 v[80:83], v14 offset:32768
    s_setprio 2
    v_exp_f32 v21, v21
    v_exp_f32 v22, v22
    v_exp_f32 v23, v23
    v_exp_f32 v24, v24
    v_exp_f32 v25, v25
    v_exp_f32 v26, v26
    v_smfmac_f32_32x32x32_bf16 v[48:63], v[88:91], v[16:23], v12
    v_exp_f32 v27, v27
    v_exp_f32 v28, v28
    v_exp_f32 v29, v29
    buffer_load_dwordx4 v[204:207], v15, s[52:55], s88 offen offset:3072 sc1
    s_add_u32 s88, s88, 4096
    v_exp_f32 v30, v30
    v_exp_f32 v31, v31
    s_setprio 0
    v_exp_f32 v32, v32
    v_exp_f32 v33, v33
    v_smfmac_f32_32x32x32_bf16 v[48:63], v[92:95], v[24:31], v12
    s_mov_b64 exec, s[14:15]
    ds_read_b128 v[88:91], v14 offset:33792
    ds_read_b128 v[92:95], v14 offset:34048
    s_mov_b64 exec, -1
    v_exp_f32 v34, v34
    v_exp_f32 v35, v35
    v_exp_f32 v36, v36
    s_waitcnt lgkmcnt(2)
    v_mfma_f32_32x32x16_bf16 v[16:31], v[80:83], v[104:107], v[64:79]
    ds_read_b128 v[80:83], v14 offset:36864
    s_setprio 2
    v_exp_f32 v37, v37
    v_exp_f32 v38, v38
    v_exp_f32 v39, v39
    v_exp_f32 v40, v40
    v_exp_f32 v41, v41
    v_exp_f32 v42, v42
    v_smfmac_f32_32x32x32_bf16 v[48:63], v[96:99], v[32:39], v12
    v_exp_f32 v43, v43
    v_exp_f32 v44, v44
    v_exp_f32 v45, v45
    buffer_load_dwordx4 v[208:211], v15, s[52:55], s88 offen offset:0 sc1
    v_exp_f32 v46, v46
    v_exp_f32 v47, v47
    s_setprio 0
    v_exp_f32 v16, v16
    v_exp_f32 v17, v17
    v_smfmac_f32_32x32x32_bf16 v[48:63], v[100:103], v[40:47], v12
    s_mov_b64 exec, s[14:15]
    ds_read_b128 v[96:99], v14 offset:37888
    ds_read_b128 v[100:103], v14 offset:38144
    s_mov_b64 exec, -1
    v_exp_f32 v18, v18
    v_exp_f32 v19, v19
    v_exp_f32 v20, v20
    s_waitcnt lgkmcnt(2)
    v_mfma_f32_32x32x16_bf16 v[32:47], v[80:83], v[104:107], v[64:79]
    ds_read_b128 v[80:83], v14 offset:40960
    s_setprio 2
    v_exp_f32 v21, v21
    v_exp_f32 v22, v22
    v_exp_f32 v23, v23
    v_exp_f32 v24, v24
    s_waitcnt vmcnt(3)
    v_mov_b32 v2, 157696
    v_mov_b32 v3, 1
    s_mov_b64 exec, 1
    ds_add_u32 v2, v3 offset:4
    s_mov_b64 exec, -1
    v_exp_f32 v25, v25
    v_exp_f32 v26, v26
    v_smfmac_f32_32x32x32_bf16 v[48:63], v[88:91], v[16:23], v12
    v_exp_f32 v27, v27
    v_exp_f32 v28, v28
    v_exp_f32 v29, v29
    buffer_load_dwordx4 v[212:215], v15, s[52:55], s88 offen offset:1024 sc1
    v_exp_f32 v30, v30
    v_exp_f32 v31, v31
    s_setprio 0
    v_exp_f32 v32, v32
    v_exp_f32 v33, v33
    v_smfmac_f32_32x32x32_bf16 v[48:63], v[92:95], v[24:31], v12
    s_mov_b64 exec, s[14:15]
    ds_read_b128 v[88:91], v14 offset:41984
    ds_read_b128 v[92:95], v14 offset:42240
    s_mov_b64 exec, -1
    v_exp_f32 v34, v34
    v_exp_f32 v35, v35
    v_exp_f32 v36, v36
    s_waitcnt lgkmcnt(3)
    v_mfma_f32_32x32x16_bf16 v[16:31], v[80:83], v[104:107], v[64:79]
    ds_read_b128 v[80:83], v14 offset:45056
    s_setprio 2
    v_exp_f32 v37, v37
    v_exp_f32 v38, v38
    v_exp_f32 v39, v39
    v_exp_f32 v40, v40
    v_exp_f32 v41, v41
    v_exp_f32 v42, v42
    v_smfmac_f32_32x32x32_bf16 v[48:63], v[96:99], v[32:39], v12
    v_exp_f32 v43, v43
    v_exp_f32 v44, v44
    v_exp_f32 v45, v45
    buffer_load_dwordx4 v[216:219], v15, s[52:55], s88 offen offset:2048 sc1
    v_exp_f32 v46, v46
    v_exp_f32 v47, v47
    v_mov_b32 v9, 157696
    ds_read_b32 v9, v9 offset:4
    s_setprio 0
    v_exp_f32 v16, v16
    v_exp_f32 v17, v17
    v_smfmac_f32_32x32x32_bf16 v[48:63], v[100:103], v[40:47], v12
    s_mov_b64 exec, s[14:15]
    ds_read_b128 v[96:99], v14 offset:46080
    ds_read_b128 v[100:103], v14 offset:46336
    s_mov_b64 exec, -1
    v_exp_f32 v18, v18
    v_exp_f32 v19, v19
    v_exp_f32 v20, v20
    s_waitcnt lgkmcnt(3)
    s_waitcnt lgkmcnt(2)
    v_readfirstlane_b32 s12, v9
    s_cmp_lg_u32 s12, 8
    s_cbranch_scc1 L_sbs_37
L_sbo_38:
    ds_read_b64_tr_b16 v[4:5], v252
    ds_read_b64_tr_b16 v[6:7], v252 offset:512
    v_mfma_f32_32x32x16_bf16 v[32:47], v[80:83], v[104:107], v[64:79]
    ds_read_b128 v[80:83], v14 offset:49152
    s_setprio 2
    v_exp_f32 v21, v21
    v_exp_f32 v22, v22
    v_exp_f32 v23, v23
    v_exp_f32 v24, v24
    v_exp_f32 v25, v25
    v_exp_f32 v26, v26
    v_smfmac_f32_32x32x32_bf16 v[48:63], v[88:91], v[16:23], v12
    v_exp_f32 v27, v27
    v_exp_f32 v28, v28
    v_exp_f32 v29, v29
    buffer_load_dwordx4 v[220:223], v15, s[52:55], s88 offen offset:3072 sc1
    s_add_u32 s88, s88, 61440
    v_exp_f32 v30, v30
    v_exp_f32 v31, v31
    s_mul_i32 s9, s5, 2304
    s_add_u32 s9, s9, 131072
    v_add_u32 v2, s9, v15
    s_waitcnt lgkmcnt(1)
    ds_write_b128 v253, v[4:7]
    ds_read_b128 v[4:7], v2
    s_setprio 0
    v_exp_f32 v32, v32
    v_exp_f32 v33, v33
    v_smfmac_f32_32x32x32_bf16 v[48:63], v[92:95], v[24:31], v12
    s_mov_b64 exec, s[14:15]
    ds_read_b128 v[88:91], v14 offset:50176
    ds_read_b128 v[92:95], v14 offset:50432
    s_mov_b64 exec, -1
    v_exp_f32 v34, v34
    v_exp_f32 v35, v35
    v_exp_f32 v36, v36
    s_waitcnt lgkmcnt(4)
    v_mfma_f32_32x32x16_bf16 v[16:31], v[80:83], v[104:107], v[64:79]
    ds_read_b128 v[80:83], v14 offset:53248
    s_setprio 2
    v_exp_f32 v37, v37
    v_exp_f32 v38, v38
    v_exp_f32 v39, v39
    v_exp_f32 v40, v40
    s_and_b32 s9, s4, 31
    s_lshl_b32 s9, s9, 17
    s_lshl_b32 s10, s5, 14
    s_add_u32 s9, s9, s10
    s_lshr_b32 s10, s4, 5
    s_lshl_b32 s10, s10, 7
    s_add_u32 s9, s9, s10
    s_waitcnt lgkmcnt(3)
    s_bitcmp1_b32 s101, 3
    s_cbranch_scc1 L_noyo
    buffer_store_dwordx4 v[4:7], v254, s[56:59], s9 offen
L_noyo:
    v_exp_f32 v41, v41
    v_exp_f32 v42, v42
    v_smfmac_f32_32x32x32_bf16 v[48:63], v[96:99], v[32:39], v12
    v_exp_f32 v43, v43
    v_exp_f32 v44, v44
    v_exp_f32 v45, v45
    buffer_load_dwordx4 v[224:227], v15, s[52:55], s88 offen offset:0 sc1
    v_exp_f32 v46, v46
    v_exp_f32 v47, v47
    s_setprio 0
    v_exp_f32 v16, v16
    v_exp_f32 v17, v17
    v_smfmac_f32_32x32x32_bf16 v[48:63], v[100:103], v[40:47], v12
    s_mov_b64 exec, s[14:15]
    ds_read_b128 v[96:99], v14 offset:54272
    ds_read_b128 v[100:103], v14 offset:54528
    s_mov_b64 exec, -1
    v_exp_f32 v18, v18
    v_exp_f32 v19, v19
    v_exp_f32 v20, v20
    s_waitcnt lgkmcnt(2)
    v_mfma_f32_32x32x16_bf16 v[32:47], v[80:83], v[104:107], v[64:79]
    ds_read_b128 v[80:83], v14 offset:57344
    s_setprio 2
    v_exp_f32 v21, v21
    v_exp_f32 v22, v22
    v_exp_f32 v23, v23
    v_exp_f32 v24, v24
    v_exp_f32 v25, v25
    v_exp_f32 v26, v26
    v_smfmac_f32_32x32x32_bf16 v[48:63], v[88:91], v[16:23], v12
    v_exp_f32 v27, v27
    v_exp_f32 v28, v28
    v_exp_f32 v29, v29
    buffer_load_dwordx4 v[228:231], v15, s[52:55], s88 offen offset:1024 sc1
    v_exp_f32 v30, v30
    v_exp_f32 v31, v31
    s_setprio 0
    v_exp_f32 v32, v32
    v_exp_f32 v33, v33
    v_smfmac_f32_32x32x32_bf16 v[48:63], v[92:95], v[24:31], v12
    s_mov_b64 exec, s[14:15]
    ds_read_b128 v[88:91], v14 offset:58368
    ds_read_b128 v[92:95], v14 offset:58624
    s_mov_b64 exec, -1
    v_exp_f32 v34, v34
    v_exp_f32 v35, v35
    v_exp_f32 v36, v36
    s_waitcnt lgkmcnt(2)
    v_mfma_f32_32x32x16_bf16 v[16:31], v[80:83], v[104:107], v[64:79]
    ds_read_b128 v[80:83], v14 offset:61440
    s_setprio 2
    v_exp_f32 v37, v37
    v_exp_f32 v38, v38
    v_exp_f32 v39, v39
    v_exp_f32 v40, v40
    v_exp_f32 v41, v41
    v_exp_f32 v42, v42
    v_smfmac_f32_32x32x32_bf16 v[48:63], v[96:99], v[32:39], v12
    v_exp_f32 v43, v43
    v_exp_f32 v44, v44
    v_exp_f32 v45, v45
    buffer_load_dwordx4 v[232:235], v15, s[52:55], s88 offen offset:2048 sc1
    v_exp_f32 v46, v46
    v_exp_f32 v47, v47
    s_setprio 0
    v_exp_f32 v16, v16
    v_exp_f32 v17, v17
    v_smfmac_f32_32x32x32_bf16 v[48:63], v[100:103], v[40:47], v12
    s_mov_b64 exec, s[14:15]
    ds_read_b128 v[96:99], v14 offset:62464
    ds_read_b128 v[100:103], v14 offset:62720
    s_mov_b64 exec, -1
    v_exp_f32 v18, v18
    v_exp_f32 v19, v19
    v_exp_f32 v20, v20
    s_waitcnt lgkmcnt(2)
    v_mfma_f32_32x32x16_bf16 v[32:47], v[80:83], v[104:107], v[64:79]
    v_xor_b32 v0, 0x10000, v14
    ds_read_b128 v[80:83], v0 offset:0
    s_setprio 2
    v_exp_f32 v21, v21
    v_exp_f32 v22, v22
    v_exp_f32 v23, v23
    v_exp_f32 v24, v24
    v_exp_f32 v25, v25
    v_exp_f32 v26, v26
    v_smfmac_f32_32x32x32_bf16 v[48:63], v[88:91], v[16:23], v12
    v_exp_f32 v27, v27
    v_exp_f32 v28, v28
    v_exp_f32 v29, v29
    buffer_load_dwordx4 v[236:239], v15, s[52:55], s88 offen offset:3072 sc1
    s_add_u32 s88, s88, 4096
    s_bitcmp0_b32 s101, 1
    s_cbranch_scc1 L_nocrew
    v_mov_b32 v2, v11
    v_mov_b32 v3, v11
    v_mov_b64 v[64:65], v[2:3]
    v_mov_b64 v[66:67], v[2:3]
    v_mov_b64 v[68:69], v[2:3]
    v_mov_b64 v[70:71], v[2:3]
    v_mov_b64 v[72:73], v[2:3]
    v_mov_b64 v[74:75], v[2:3]
    v_mov_b64 v[76:77], v[2:3]
    v_mov_b64 v[78:79], v[2:3]
L_nocrew:
    v_exp_f32 v30, v30
    v_exp_f32 v31, v31
    s_setprio 0
    v_exp_f32 v32, v32
    v_exp_f32 v33, v33
    v_smfmac_f32_32x32x32_bf16 v[48:63], v[92:95], v[24:31], v12
    v_mov_b32 v14, v0
    s_mov_b64 exec, s[14:15]
    ds_read_b128 v[88:91], v14 offset:1024
    ds_read_b128 v[92:95], v14 offset:1280
    s_mov_b64 exec, -1
    v_exp_f32 v34, v34
    v_exp_f32 v35, v35
    v_exp_f32 v36, v36
    s_waitcnt lgkmcnt(2)
    v_mfma_f32_32x32x16_bf16 v[16:31], v[80:83], v[108:111], v[64:79]
    ds_read_b128 v[80:83], v14 offset:4096
    s_setprio 2
    v_exp_f32 v37, v37
    v_exp_f32 v38, v38
    v_exp_f32 v39, v39
    v_exp_f32 v40, v40
    v_exp_f32 v41, v41
    v_exp_f32 v42, v42
    v_smfmac_f32_32x32x32_bf16 v[48:63], v[96:99], v[32:39], v12
    v_exp_f32 v43, v43
    v_exp_f32 v44, v44
    v_exp_f32 v45, v45
    buffer_load_dwordx4 v[240:243], v15, s[52:55], s88 offen offset:0 sc1
    v_exp_f32 v46, v46
    v_exp_f32 v47, v47
    s_setprio 0
    v_exp_f32 v16, v16
    v_exp_f32 v17, v17
    v_smfmac_f32_32x32x32_bf16 v[48:63], v[100:103], v[40:47], v12
    s_mov_b64 exec, s[14:15]
    ds_read_b128 v[96:99], v14 offset:5120
    ds_read_b128 v[100:103], v14 offset:5376
    s_mov_b64 exec, -1
    v_exp_f32 v18, v18
    v_exp_f32 v19, v19
    v_exp_f32 v20, v20
    s_waitcnt lgkmcnt(2)
    s_mul_i32 s9, s5, 2304
    s_add_u32 s9, s9, 131072
    v_add_u32 v2, s9, v15
    v_lshl_add_u32 v3, v1, 2, s9
    v_mfma_f32_32x32x16_bf16 v[32:47], v[80:83], v[108:111], v[64:79]
    ds_read_b128 v[80:83], v14 offset:8192
    s_setprio 2
    v_exp_f32 v21, v21
    v_exp_f32 v22, v22
    v_exp_f32 v23, v23
    v_exp_f32 v24, v24
    v_exp_f32 v25, v25
    v_exp_f32 v26, v26
    v_exp_f32 v27, v27
    v_exp_f32 v28, v28
    v_exp_f32 v29, v29
    buffer_load_dwordx4 v[244:247], v15, s[52:55], s88 offen offset:1024 sc1
    ds_write_b128 v2, v[48:51]
    ds_write_b128 v2, v[52:55] offset:1024
    ds_write_b32 v3, v56 offset:2048
    v_mov_b32 v2, 157696
    v_mov_b32 v3, 1
    s_mov_b64 exec, 1
    ds_add_u32 v2, v3 offset:8
    s_mov_b64 exec, -1
    v_mov_b64 v[48:49], 0
    v_mov_b64 v[50:51], 0
    v_mov_b64 v[52:53], 0
    v_mov_b64 v[54:55], 0
    v_mov_b64 v[56:57], 0
    v_exp_f32 v30, v30
    v_exp_f32 v31, v31
    v_smfmac_f32_32x32x32_bf16 v[48:63], v[88:91], v[16:23], v12
    s_setprio 0
    v_exp_f32 v32, v32
    v_exp_f32 v33, v33
    v_smfmac_f32_32x32x32_bf16 v[48:63], v[92:95], v[24:31], v12
    s_mov_b64 exec, s[14:15]
    ds_read_b128 v[88:91], v14 offset:9216
    ds_read_b128 v[92:95], v14 offset:9472
    s_mov_b64 exec, -1
    v_exp_f32 v34, v34
    v_exp_f32 v35, v35
    v_exp_f32 v36, v36
    s_waitcnt lgkmcnt(6)
    v_mfma_f32_32x32x16_bf16 v[16:31], v[80:83], v[108:111], v[64:79]
    ds_read_b128 v[80:83], v14 offset:12288
    s_setprio 2
    v_exp_f32 v37, v37
    v_exp_f32 v38, v38
    v_exp_f32 v39, v39
    v_exp_f32 v40, v40
    v_exp_f32 v41, v41
    v_exp_f32 v42, v42
    v_smfmac_f32_32x32x32_bf16 v[48:63], v[96:99], v[32:39], v12
    v_exp_f32 v43, v43
    v_exp_f32 v44, v44
    v_exp_f32 v45, v45
    buffer_load_dwordx4 v[248:251], v15, s[52:55], s88 offen offset:2048 sc1
    v_exp_f32 v46, v46
    v_exp_f32 v47, v47
    s_setprio 0
    v_exp_f32 v16, v16
    v_exp_f32 v17, v17
    v_smfmac_f32_32x32x32_bf16 v[48:63], v[100:103], v[40:47], v12
    s_mov_b64 exec, s[14:15]
    ds_read_b128 v[96:99], v14 offset:13312
    ds_read_b128 v[100:103], v14 offset:13568
    s_mov_b64 exec, -1
    v_exp_f32 v18, v18
    v_exp_f32 v19, v19
    v_exp_f32 v20, v20
    s_waitcnt lgkmcnt(2)
    v_mfma_f32_32x32x16_bf16 v[32:47], v[80:83], v[108:111], v[64:79]
    ds_read_b128 v[80:83], v14 offset:16384
    s_setprio 2
    v_exp_f32 v21, v21
    v_exp_f32 v22, v22
    v_exp_f32 v23, v23
    v_exp_f32 v24, v24
    v_exp_f32 v25, v25
    v_exp_f32 v26, v26
    v_smfmac_f32_32x32x32_bf16 v[48:63], v[88:91], v[16:23], v12
    v_exp_f32 v27, v27
    v_exp_f32 v28, v28
    v_exp_f32 v29, v29
    buffer_load_dwordx4 v[252:255], v15, s[52:55], s88 offen offset:3072 sc1
    s_add_u32 s88, s88, 61440
    v_exp_f32 v30, v30
    v_exp_f32 v31, v31
    v_mov_b32 v9, 157696
    ds_read_b32 v9, v9 offset:8
    s_setprio 0
    v_exp_f32 v32, v32
    v_exp_f32 v33, v33
    v_smfmac_f32_32x32x32_bf16 v[48:63], v[92:95], v[24:31], v12
    s_mov_b64 exec, s[14:15]
    ds_read_b128 v[88:91], v14 offset:17408
    ds_read_b128 v[92:95], v14 offset:17664
    s_mov_b64 exec, -1
    v_exp_f32 v34, v34
    v_exp_f32 v35, v35
    v_exp_f32 v36, v36
    s_waitcnt lgkmcnt(3)
    s_and_b32 s9, s5, 3
    s_mul_i32 s10, s9, 2304
    s_add_u32 s10, s10, 131072
    s_lshl_b32 s11, s90, 10
    s_add_u32 s11, s11, s10
    v_add_u32 v2, s11, v15
    v_lshl_add_u32 v3, v1, 2, s10
    s_waitcnt lgkmcnt(2)
    v_readfirstlane_b32 s12, v9
    s_cmp_lg_u32 s12, 8
    s_cbranch_scc1 L_sbs_39
L_sbo_40:
    ds_read_b32 v8, v3 offset:2048
    ds_read_b32 v9, v3 offset:11264
    ds_read_b128 v[4:7], v2
    ds_read_b128 v[84:87], v2 offset:9216
    v_and_b32 v2, 31, v1
    v_lshlrev_b32 v2, 5, v2
    v_lshrrev_b32 v3, 5, v1
    v_lshl_add_u32 v2, v3, 4, v2
    s_lshl_b32 s9, s9, 10
    s_lshl_b32 s10, s90, 3
    s_add_u32 s9, s9, s10
    s_add_u32 s9, s9, 149504
    v_add_u32 v2, s9, v2
    v_mfma_f32_32x32x16_bf16 v[16:31], v[80:83], v[108:111], v[64:79]
    ds_read_b128 v[80:83], v14 offset:20480
    s_setprio 2
    v_exp_f32 v37, v37
    v_exp_f32 v38, v38
    v_exp_f32 v39, v39
    v_exp_f32 v40, v40
    v_exp_f32 v41, v41
    v_exp_f32 v42, v42
    v_smfmac_f32_32x32x32_bf16 v[48:63], v[96:99], v[32:39], v12
    v_exp_f32 v43, v43
    v_exp_f32 v44, v44
    v_exp_f32 v45, v45
    s_waitcnt lgkmcnt(1)
    v_add_f32 v8, v8, v9
    v_rcp_f32 v8, v8
    v_pk_add_f32 v[4:5], v[4:5], v[84:85]
    v_pk_add_f32 v[6:7], v[6:7], v[86:87]
    v_pk_mul_f32 v[4:5], v[4:5], v[8:9] op_sel_hi:[1,0]
    v_pk_mul_f32 v[6:7], v[6:7], v[8:9] op_sel_hi:[1,0]
    v_cvt_pk_bf16_f32 v4, v4, v5
    v_cvt_pk_bf16_f32 v5, v6, v7
    ds_write_b64 v2, v[4:5]
    v_mov_b32 v2, 157696
    v_mov_b32 v3, 1
    s_mov_b64 exec, 1
    ds_add_u32 v2, v3 offset:12
    s_mov_b64 exec, -1
    v_exp_f32 v46, v46
    v_exp_f32 v47, v47
    s_setprio 0
    v_exp_f32 v16, v16
    v_exp_f32 v17, v17
    v_smfmac_f32_32x32x32_bf16 v[48:63], v[100:103], v[40:47], v12
    s_mov_b64 exec, s[14:15]
    ds_read_b128 v[96:99], v14 offset:21504
    ds_read_b128 v[100:103], v14 offset:21760
    s_mov_b64 exec, -1
    v_exp_f32 v18, v18
    v_exp_f32 v19, v19
    v_exp_f32 v20, v20
    s_waitcnt lgkmcnt(4)
    v_mfma_f32_32x32x16_bf16 v[32:47], v[80:83], v[108:111], v[64:79]
    ds_read_b128 v[80:83], v14 offset:24576
    s_setprio 2
    v_exp_f32 v21, v21
    v_exp_f32 v22, v22
    v_exp_f32 v23, v23
    v_exp_f32 v24, v24
    v_exp_f32 v25, v25
    v_exp_f32 v26, v26
    v_smfmac_f32_32x32x32_bf16 v[48:63], v[88:91], v[16:23], v12
    v_exp_f32 v27, v27
    v_exp_f32 v28, v28
    v_exp_f32 v29, v29
    v_exp_f32 v30, v30
    v_exp_f32 v31, v31
    s_setprio 0
    v_exp_f32 v32, v32
    v_exp_f32 v33, v33
    v_smfmac_f32_32x32x32_bf16 v[48:63], v[92:95], v[24:31], v12
    s_mov_b64 exec, s[14:15]
    ds_read_b128 v[88:91], v14 offset:25600
    ds_read_b128 v[92:95], v14 offset:25856
    s_mov_b64 exec, -1
    v_exp_f32 v34, v34
    v_exp_f32 v35, v35
    v_exp_f32 v36, v36
    s_waitcnt lgkmcnt(2)
    v_mfma_f32_32x32x16_bf16 v[16:31], v[80:83], v[108:111], v[64:79]
    ds_read_b128 v[80:83], v14 offset:28672
    s_setprio 2
    v_exp_f32 v37, v37
    v_exp_f32 v38, v38
    v_exp_f32 v39, v39
    v_exp_f32 v40, v40
    v_exp_f32 v41, v41
    v_exp_f32 v42, v42
    v_smfmac_f32_32x32x32_bf16 v[48:63], v[96:99], v[32:39], v12
    v_exp_f32 v43, v43
    v_exp_f32 v44, v44
    v_exp_f32 v45, v45
    v_exp_f32 v46, v46
    v_exp_f32 v47, v47
    v_mov_b32 v9, 157696
    ds_read_b32 v9, v9 offset:12
    s_setprio 0
    v_exp_f32 v16, v16
    v_exp_f32 v17, v17
    v_smfmac_f32_32x32x32_bf16 v[48:63], v[100:103], v[40:47], v12
    s_mov_b64 exec, s[14:15]
    ds_read_b128 v[96:99], v14 offset:29696
    ds_read_b128 v[100:103], v14 offset:29952
    s_mov_b64 exec, -1
    v_exp_f32 v18, v18
    v_exp_f32 v19, v19
    v_exp_f32 v20, v20
    s_waitcnt lgkmcnt(3)
    v_add_u32 v2, 149504, v15
    s_waitcnt lgkmcnt(2)
    v_readfirstlane_b32 s12, v9
    s_cmp_lg_u32 s12, 8
    s_cbranch_scc1 L_sbs_41
L_sbo_42:
    ds_read_b128 v[84:87], v2
    ds_read_b128 v[4:7], v2 offset:1024
    v_mfma_f32_32x32x16_bf16 v[32:47], v[80:83], v[108:111], v[64:79]
    ds_read_b128 v[80:83], v14 offset:32768
    s_setprio 2
    v_exp_f32 v21, v21
    v_exp_f32 v22, v22
    v_exp_f32 v23, v23
    v_exp_f32 v24, v24
    s_waitcnt lgkmcnt(2)
    v_smfmac_f32_16x16x64_bf16 v[112:115], v[84:87], v[128:135], v13
    v_smfmac_f32_16x16x64_bf16 v[116:119], v[84:87], v[136:143], v13
    v_exp_f32 v25, v25
    v_exp_f32 v26, v26
    v_smfmac_f32_32x32x32_bf16 v[48:63], v[88:91], v[16:23], v12
    v_exp_f32 v27, v27
    v_exp_f32 v28, v28
    v_exp_f32 v29, v29
    v_smfmac_f32_16x16x64_bf16 v[120:123], v[84:87], v[144:151], v13
    v_smfmac_f32_16x16x64_bf16 v[124:127], v[84:87], v[152:159], v13
    v_exp_f32 v30, v30
    v_exp_f32 v31, v31
    s_setprio 0
    v_exp_f32 v32, v32
    v_exp_f32 v33, v33
    v_smfmac_f32_32x32x32_bf16 v[48:63], v[92:95], v[24:31], v12
    s_mov_b64 exec, s[14:15]
    ds_read_b128 v[88:91], v14 offset:33792
    ds_read_b128 v[92:95], v14 offset:34048
    s_mov_b64 exec, -1
    v_exp_f32 v34, v34
    v_exp_f32 v35, v35
    v_exp_f32 v36, v36
    s_waitcnt lgkmcnt(2)
    ds_read_b128 v[84:87], v2 offset:2048
    v_mfma_f32_32x32x16_bf16 v[16:31], v[80:83], v[108:111], v[64:79]
    ds_read_b128 v[80:83], v14 offset:36864
    s_setprio 2
    v_exp_f32 v37, v37
    v_exp_f32 v38, v38
    v_exp_f32 v39, v39
    v_exp_f32 v40, v40
    v_smfmac_f32_16x16x64_bf16 v[112:115], v[4:7], v[160:167], v13
    v_smfmac_f32_16x16x64_bf16 v[116:119], v[4:7], v[168:175], v13
    v_exp_f32 v41, v41
    v_exp_f32 v42, v42
    v_smfmac_f32_32x32x32_bf16 v[48:63], v[96:99], v[32:39], v12
    v_exp_f32 v43, v43
    v_exp_f32 v44, v44
    v_exp_f32 v45, v45
    v_smfmac_f32_16x16x64_bf16 v[120:123], v[4:7], v[176:183], v13
    v_smfmac_f32_16x16x64_bf16 v[124:127], v[4:7], v[184:191], v13
    buffer_load_dwordx4 v[128:131], v15, s[52:55], s88 offen offset:0 sc1
    v_exp_f32 v46, v46
    v_exp_f32 v47, v47
    s_setprio 0
    v_exp_f32 v16, v16
    v_exp_f32 v17, v17
    v_smfmac_f32_32x32x32_bf16 v[48:63], v[100:103], v[40:47], v12
    s_mov_b64 exec, s[14:15]
    ds_read_b128 v[96:99], v14 offset:37888
    ds_read_b128 v[100:103], v14 offset:38144
    s_mov_b64 exec, -1
    v_exp_f32 v18, v18
    v_exp_f32 v19, v19
    v_exp_f32 v20, v20
    s_waitcnt lgkmcnt(2)
    ds_read_b128 v[4:7], v2 offset:3072
    v_mfma_f32_32x32x16_bf16 v[32:47], v[80:83], v[108:111], v[64:79]
    ds_read_b128 v[80:83], v14 offset:40960
    s_setprio 2
    v_exp_f32 v21, v21
    v_exp_f32 v22, v22
    v_exp_f32 v23, v23
    v_exp_f32 v24, v24
    s_waitcnt vmcnt(9)
    v_smfmac_f32_16x16x64_bf16 v[112:115], v[84:87], v[192:199], v13
    v_smfmac_f32_16x16x64_bf16 v[116:119], v[84:87], v[200:207], v13
    v_exp_f32 v25, v25
    v_exp_f32 v26, v26
    v_smfmac_f32_32x32x32_bf16 v[48:63], v[88:91], v[16:23], v12
    v_exp_f32 v27, v27
    v_exp_f32 v28, v28
    v_exp_f32 v29, v29
    v_smfmac_f32_16x16x64_bf16 v[120:123], v[84:87], v[208:215], v13
    v_smfmac_f32_16x16x64_bf16 v[124:127], v[84:87], v[216:223], v13
    buffer_load_dwordx4 v[132:135], v15, s[52:55], s88 offen offset:1024 sc1
    v_exp_f32 v30, v30
    v_exp_f32 v31, v31
    s_setprio 0
    v_exp_f32 v32, v32
    v_exp_f32 v33, v33
    v_smfmac_f32_32x32x32_bf16 v[48:63], v[92:95], v[24:31], v12
    s_mov_b64 exec, s[14:15]
    ds_read_b128 v[88:91], v14 offset:41984
    ds_read_b128 v[92:95], v14 offset:42240
    s_mov_b64 exec, -1
    v_exp_f32 v34, v34
    v_exp_f32 v35, v35
    v_exp_f32 v36, v36
    s_waitcnt lgkmcnt(2)
    v_mfma_f32_32x32x16_bf16 v[16:31], v[80:83], v[108:111], v[64:79]
    ds_read_b128 v[80:83], v14 offset:45056
    s_setprio 2
    v_exp_f32 v37, v37
    v_exp_f32 v38, v38
    v_exp_f32 v39, v39
    v_exp_f32 v40, v40
    s_waitcnt vmcnt(2)
    v_smfmac_f32_16x16x64_bf16 v[112:115], v[4:7], v[224:231], v13
    v_smfmac_f32_16x16x64_bf16 v[116:119], v[4:7], v[232:239], v13
    v_exp_f32 v41, v41
    v_exp_f32 v42, v42
    v_smfmac_f32_32x32x32_bf16 v[48:63], v[96:99], v[32:39], v12
    v_exp_f32 v43, v43
    v_exp_f32 v44, v44
    v_exp_f32 v45, v45
    v_smfmac_f32_16x16x64_bf16 v[120:123], v[4:7], v[240:247], v13
    v_smfmac_f32_16x16x64_bf16 v[124:127], v[4:7], v[248:255], v13
    buffer_load_dwordx4 v[136:139], v15, s[52:55], s88 offen offset:2048 sc1
    v_exp_f32 v46, v46
    v_exp_f32 v47, v47
    s_setprio 0
    v_exp_f32 v16, v16
    v_exp_f32 v17, v17
    v_smfmac_f32_32x32x32_bf16 v[48:63], v[100:103], v[40:47], v12
    s_mov_b64 exec, s[14:15]
    ds_read_b128 v[96:99], v14 offset:46080
    ds_read_b128 v[100:103], v14 offset:46336
    s_mov_b64 exec, -1
    v_exp_f32 v18, v18
    v_exp_f32 v19, v19
    v_exp_f32 v20, v20
    s_waitcnt lgkmcnt(2)
    v_mfma_f32_32x32x16_bf16 v[32:47], v[80:83], v[108:111], v[64:79]
    ds_read_b128 v[80:83], v14 offset:49152
    s_setprio 2
    v_exp_f32 v21, v21
    v_exp_f32 v22, v22
    v_exp_f32 v23, v23
    v_exp_f32 v24, v24
    v_exp_f32 v25, v25
    v_exp_f32 v26, v26
    v_smfmac_f32_32x32x32_bf16 v[48:63], v[88:91], v[16:23], v12
    v_exp_f32 v27, v27
    v_exp_f32 v28, v28
    v_exp_f32 v29, v29
    buffer_load_dwordx4 v[140:143], v15, s[52:55], s88 offen offset:3072 sc1
    s_add_u32 s88, s88, 4096
    buffer_load_dwordx4 v[144:147], v15, s[52:55], s88 offen offset:0 sc1
    v_exp_f32 v30, v30
    v_exp_f32 v31, v31
    s_setprio 0
    v_exp_f32 v32, v32
    v_exp_f32 v33, v33
    v_smfmac_f32_32x32x32_bf16 v[48:63], v[92:95], v[24:31], v12
    s_mov_b64 exec, s[14:15]
    ds_read_b128 v[88:91], v14 offset:50176
    ds_read_b128 v[92:95], v14 offset:50432
    s_mov_b64 exec, -1
    v_exp_f32 v34, v34
    v_exp_f32 v35, v35
    v_exp_f32 v36, v36
    s_waitcnt lgkmcnt(2)
    v_mfma_f32_32x32x16_bf16 v[16:31], v[80:83], v[108:111], v[64:79]
    ds_read_b128 v[80:83], v14 offset:53248
    s_setprio 2
    v_exp_f32 v37, v37
    v_exp_f32 v38, v38
    v_exp_f32 v39, v39
    v_exp_f32 v40, v40
    v_exp_f32 v41, v41
    v_exp_f32 v42, v42
    v_smfmac_f32_32x32x32_bf16 v[48:63], v[96:99], v[32:39], v12
    v_exp_f32 v43, v43
    v_exp_f32 v44, v44
    v_exp_f32 v45, v45
    buffer_load_dwordx4 v[148:151], v15, s[52:55], s88 offen offset:1024 sc1
    v_exp_f32 v46, v46
    v_exp_f32 v47, v47
    s_setprio 0
    v_exp_f32 v16, v16
    v_exp_f32 v17, v17
    v_smfmac_f32_32x32x32_bf16 v[48:63], v[100:103], v[40:47], v12
    s_mov_b64 exec, s[14:15]
    ds_read_b128 v[96:99], v14 offset:54272
    ds_read_b128 v[100:103], v14 offset:54528
    s_mov_b64 exec, -1
    v_exp_f32 v18, v18
    v_exp_f32 v19, v19
    v_exp_f32 v20, v20
    s_waitcnt lgkmcnt(2)
    v_mfma_f32_32x32x16_bf16 v[32:47], v[80:83], v[108:111], v[64:79]
    ds_read_b128 v[80:83], v14 offset:57344
    s_setprio 2
    v_exp_f32 v21, v21
    v_exp_f32 v22, v22
    v_exp_f32 v23, v23
    v_exp_f32 v24, v24
    v_exp_f32 v25, v25
    v_exp_f32 v26, v26
    v_smfmac_f32_32x32x32_bf16 v[48:63], v[88:91], v[16:23], v12
    v_exp_f32 v27, v27
    v_exp_f32 v28, v28
    v_exp_f32 v29, v29
    buffer_load_dwordx4 v[152:155], v15, s[52:55], s88 offen offset:2048 sc1
    buffer_load_dwordx4 v[156:159], v15, s[52:55], s88 offen offset:3072 sc1
    s_add_u32 s88, s88, 61440
    v_exp_f32 v30, v30
    v_exp_f32 v31, v31
    s_setprio 0
    v_exp_f32 v32, v32
    v_exp_f32 v33, v33
    v_smfmac_f32_32x32x32_bf16 v[48:63], v[92:95], v[24:31], v12
    s_mov_b64 exec, s[14:15]
    ds_read_b128 v[88:91], v14 offset:58368
    ds_read_b128 v[92:95], v14 offset:58624
    s_mov_b64 exec, -1
    v_exp_f32 v34, v34
    v_exp_f32 v35, v35
    v_exp_f32 v36, v36
    s_waitcnt lgkmcnt(2)
    v_mfma_f32_32x32x16_bf16 v[16:31], v[80:83], v[108:111], v[64:79]
    ds_read_b128 v[80:83], v14 offset:61440
    s_setprio 2
    v_exp_f32 v37, v37
    v_exp_f32 v38, v38
    v_exp_f32 v39, v39
    v_exp_f32 v40, v40
    v_exp_f32 v41, v41
    v_exp_f32 v42, v42
    v_smfmac_f32_32x32x32_bf16 v[48:63], v[96:99], v[32:39], v12
    v_exp_f32 v43, v43
    v_exp_f32 v44, v44
    v_exp_f32 v45, v45
    buffer_load_dwordx4 v[160:163], v15, s[52:55], s88 offen offset:0 sc1
    v_exp_f32 v46, v46
    v_exp_f32 v47, v47
    s_setprio 0
    v_exp_f32 v16, v16
    v_exp_f32 v17, v17
    v_smfmac_f32_32x32x32_bf16 v[48:63], v[100:103], v[40:47], v12
    s_mov_b64 exec, s[14:15]
    ds_read_b128 v[96:99], v14 offset:62464
    ds_read_b128 v[100:103], v14 offset:62720
    s_mov_b64 exec, -1
    v_exp_f32 v18, v18
    v_exp_f32 v19, v19
    v_exp_f32 v20, v20
    s_waitcnt lgkmcnt(2)
    v_mfma_f32_32x32x16_bf16 v[32:47], v[80:83], v[108:111], v[64:79]
    v_xor_b32 v0, 0x10000, v14
    ds_read_b128 v[80:83], v0 offset:0
    s_setprio 2
    v_exp_f32 v21, v21
    v_exp_f32 v22, v22
    v_exp_f32 v23, v23
    v_exp_f32 v24, v24
    v_exp_f32 v25, v25
    v_exp_f32 v26, v26
    v_smfmac_f32_32x32x32_bf16 v[48:63], v[88:91], v[16:23], v12
    v_exp_f32 v27, v27
    v_exp_f32 v28, v28
    v_exp_f32 v29, v29
    buffer_load_dwordx4 v[164:167], v15, s[52:55], s88 offen offset:1024 sc1
    buffer_load_dwordx4 v[168:171], v15, s[52:55], s88 offen offset:2048 sc1
    v_exp_f32 v30, v30
    v_exp_f32 v31, v31
    s_setprio 0
    v_exp_f32 v32, v32
    v_exp_f32 v33, v33
    v_smfmac_f32_32x32x32_bf16 v[48:63], v[92:95], v[24:31], v12
    v_mov_b32 v14, v0
    s_mov_b64 exec, s[14:15]
    ds_read_b128 v[88:91], v14 offset:1024
    ds_read_b128 v[92:95], v14 offset:1280
    s_mov_b64 exec, -1
    v_exp_f32 v34, v34
    v_exp_f32 v35, v35
    v_exp_f32 v36, v36
    s_waitcnt lgkmcnt(2)
    v_mfma_f32_32x32x16_bf16 v[16:31], v[80:83], v[108:111], v[64:79]
    ds_read_b128 v[80:83], v14 offset:4096
    s_setprio 2
    v_exp_f32 v37, v37
    v_exp_f32 v38, v38
    v_exp_f32 v39, v39
    v_exp_f32 v40, v40
    v_exp_f32 v41, v41
    v_exp_f32 v42, v42
    v_smfmac_f32_32x32x32_bf16 v[48:63], v[96:99], v[32:39], v12
    v_exp_f32 v43, v43
    v_exp_f32 v44, v44
    v_exp_f32 v45, v45
    buffer_load_dwordx4 v[172:175], v15, s[52:55], s88 offen offset:3072 sc1
    s_add_u32 s88, s88, 4096
    v_exp_f32 v46, v46
    v_exp_f32 v47, v47
    s_setprio 0
    v_exp_f32 v16, v16
    v_exp_f32 v17, v17
    v_smfmac_f32_32x32x32_bf16 v[48:63], v[100:103], v[40:47], v12
    s_mov_b64 exec, s[14:15]
    ds_read_b128 v[96:99], v14 offset:5120
    ds_read_b128 v[100:103], v14 offset:5376
    s_mov_b64 exec, -1
    v_exp_f32 v18, v18
    v_exp_f32 v19, v19
    v_exp_f32 v20, v20
    s_waitcnt lgkmcnt(2)
    v_mfma_f32_32x32x16_bf16 v[32:47], v[80:83], v[108:111], v[64:79]
    ds_read_b128 v[80:83], v14 offset:8192
    s_setprio 2
    v_exp_f32 v21, v21
    v_exp_f32 v22, v22
    v_exp_f32 v23, v23
    v_exp_f32 v24, v24
    v_exp_f32 v25, v25
    v_exp_f32 v26, v26
    v_smfmac_f32_32x32x32_bf16 v[48:63], v[88:91], v[16:23], v12
    v_exp_f32 v27, v27
    v_exp_f32 v28, v28
    v_exp_f32 v29, v29
    buffer_load_dwordx4 v[176:179], v15, s[52:55], s88 offen offset:0 sc1
    buffer_load_dwordx4 v[180:183], v15, s[52:55], s88 offen offset:1024 sc1
    v_exp_f32 v30, v30
    v_exp_f32 v31, v31
    s_setprio 0
    v_exp_f32 v32, v32
    v_exp_f32 v33, v33
    v_smfmac_f32_32x32x32_bf16 v[48:63], v[92:95], v[24:31], v12
    s_mov_b64 exec, s[14:15]
    ds_read_b128 v[88:91], v14 offset:9216
    ds_read_b128 v[92:95], v14 offset:9472
    s_mov_b64 exec, -1
    v_exp_f32 v34, v34
    v_exp_f32 v35, v35
    v_exp_f32 v36, v36
    s_waitcnt lgkmcnt(2)
    v_mfma_f32_32x32x16_bf16 v[16:31], v[80:83], v[108:111], v[64:79]
    ds_read_b128 v[80:83], v14 offset:12288
    s_setprio 2
    v_exp_f32 v37, v37
    v_exp_f32 v38, v38
    v_exp_f32 v39, v39
    v_exp_f32 v40, v40
    v_exp_f32 v41, v41
    v_exp_f32 v42, v42
    v_smfmac_f32_32x32x32_bf16 v[48:63], v[96:99], v[32:39], v12
    v_exp_f32 v43, v43
    v_exp_f32 v44, v44
    v_exp_f32 v45, v45
    buffer_load_dwordx4 v[184:187], v15, s[52:55], s88 offen offset:2048 sc1
    v_exp_f32 v46, v46
    v_exp_f32 v47, v47
    s_setprio 0
    v_exp_f32 v16, v16
    v_exp_f32 v17, v17
    v_smfmac_f32_32x32x32_bf16 v[48:63], v[100:103], v[40:47], v12
    s_mov_b64 exec, s[14:15]
    ds_read_b128 v[96:99], v14 offset:13312
    ds_read_b128 v[100:103], v14 offset:13568
    s_mov_b64 exec, -1
    v_exp_f32 v18, v18
    v_exp_f32 v19, v19
    v_exp_f32 v20, v20
    s_waitcnt lgkmcnt(2)
    v_mfma_f32_32x32x16_bf16 v[32:47], v[80:83], v[108:111], v[64:79]
    ds_read_b128 v[80:83], v14 offset:16384
    s_setprio 2
    v_exp_f32 v21, v21
    v_exp_f32 v22, v22
    v_exp_f32 v23, v23
    v_exp_f32 v24, v24
    v_exp_f32 v25, v25
    v_exp_f32 v26, v26
    v_smfmac_f32_32x32x32_bf16 v[48:63], v[88:91], v[16:23], v12
    v_exp_f32 v27, v27
    v_exp_f32 v28, v28
    v_exp_f32 v29, v29
    buffer_load_dwordx4 v[188:191], v15, s[52:55], s88 offen offset:3072 sc1
    s_add_u32 s88, s88, 61440
    buffer_load_dwordx4 v[192:195], v15, s[52:55], s88 offen offset:0 sc1
    v_exp_f32 v30, v30
    v_exp_f32 v31, v31
    s_setprio 0
    v_exp_f32 v32, v32
    v_exp_f32 v33, v33
    v_smfmac_f32_32x32x32_bf16 v[48:63], v[92:95], v[24:31], v12
    s_mov_b64 exec, s[14:15]
    ds_read_b128 v[88:91], v14 offset:17408
    ds_read_b128 v[92:95], v14 offset:17664
    s_mov_b64 exec, -1
    v_exp_f32 v34, v34
    v_exp_f32 v35, v35
    v_exp_f32 v36, v36
    s_waitcnt lgkmcnt(2)
    v_mfma_f32_32x32x16_bf16 v[16:31], v[80:83], v[108:111], v[64:79]
    ds_read_b128 v[80:83], v14 offset:20480
    s_setprio 2
    v_exp_f32 v37, v37
    v_exp_f32 v38, v38
    v_exp_f32 v39, v39
    v_exp_f32 v40, v40
    v_exp_f32 v41, v41
    v_exp_f32 v42, v42
    v_smfmac_f32_32x32x32_bf16 v[48:63], v[96:99], v[32:39], v12
    v_exp_f32 v43, v43
    v_exp_f32 v44, v44
    v_exp_f32 v45, v45
    buffer_load_dwordx4 v[196:199], v15, s[52:55], s88 offen offset:1024 sc1
    v_exp_f32 v46, v46
    v_exp_f32 v47, v47
    s_setprio 0
    v_exp_f32 v16, v16
    v_exp_f32 v17, v17
    v_smfmac_f32_32x32x32_bf16 v[48:63], v[100:103], v[40:47], v12
    s_mov_b64 exec, s[14:15]
    ds_read_b128 v[96:99], v14 offset:21504
    ds_read_b128 v[100:103], v14 offset:21760
    s_mov_b64 exec, -1
    v_exp_f32 v18, v18
    v_exp_f32 v19, v19
    v_exp_f32 v20, v20
    s_waitcnt lgkmcnt(2)
    v_mfma_f32_32x32x16_bf16 v[32:47], v[80:83], v[108:111], v[64:79]
    ds_read_b128 v[80:83], v14 offset:24576
    s_setprio 2
    v_exp_f32 v21, v21
    v_exp_f32 v22, v22
    v_exp_f32 v23, v23
    v_exp_f32 v24, v24
    v_exp_f32 v25, v25
    v_exp_f32 v26, v26
    v_smfmac_f32_32x32x32_bf16 v[48:63], v[88:91], v[16:23], v12
    v_exp_f32 v27, v27
    v_exp_f32 v28, v28
    v_exp_f32 v29, v29
    buffer_load_dwordx4 v[200:203], v15, s[52:55], s88 offen offset:2048 sc1
    buffer_load_dwordx4 v[204:207], v15, s[52:55], s88 offen offset:3072 sc1
    s_add_u32 s88, s88, 4096
    v_exp_f32 v30, v30
    v_exp_f32 v31, v31
    s_setprio 0
    v_exp_f32 v32, v32
    v_exp_f32 v33, v33
    v_smfmac_f32_32x32x32_bf16 v[48:63], v[92:95], v[24:31], v12
    s_mov_b64 exec, s[14:15]
    ds_read_b128 v[88:91], v14 offset:25600
    ds_read_b128 v[92:95], v14 offset:25856
    s_mov_b64 exec, -1
    v_exp_f32 v34, v34
    v_exp_f32 v35, v35
    v_exp_f32 v36, v36
    s_waitcnt lgkmcnt(2)
    v_mfma_f32_32x32x16_bf16 v[16:31], v[80:83], v[108:111], v[64:79]
    ds_read_b128 v[80:83], v14 offset:28672
    s_setprio 2
    v_exp_f32 v37, v37
    v_exp_f32 v38, v38
    v_exp_f32 v39, v39
    v_exp_f32 v40, v40
    v_exp_f32 v41, v41
    v_exp_f32 v42, v42
    v_smfmac_f32_32x32x32_bf16 v[48:63], v[96:99], v[32:39], v12
    v_exp_f32 v43, v43
    v_exp_f32 v44, v44
    v_exp_f32 v45, v45
    buffer_load_dwordx4 v[208:211], v15, s[52:55], s88 offen offset:0 sc1
    v_exp_f32 v46, v46
    v_exp_f32 v47, v47
    s_setprio 0
    v_exp_f32 v16, v16
    v_exp_f32 v17, v17
    v_smfmac_f32_32x32x32_bf16 v[48:63], v[100:103], v[40:47], v12
    s_mov_b64 exec, s[14:15]
    ds_read_b128 v[96:99], v14 offset:29696
    ds_read_b128 v[100:103], v14 offset:29952
    s_mov_b64 exec, -1
    v_exp_f32 v18, v18
    v_exp_f32 v19, v19
    v_exp_f32 v20, v20
    s_waitcnt lgkmcnt(2)
    v_mfma_f32_32x32x16_bf16 v[32:47], v[80:83], v[108:111], v[64:79]
    ds_read_b128 v[80:83], v14 offset:32768
    s_setprio 2
    v_exp_f32 v21, v21
    v_exp_f32 v22, v22
    v_exp_f32 v23, v23
    v_exp_f32 v24, v24
    v_exp_f32 v25, v25
    v_exp_f32 v26, v26
    v_smfmac_f32_32x32x32_bf16 v[48:63], v[88:91], v[16:23], v12
    v_exp_f32 v27, v27
    v_exp_f32 v28, v28
    v_exp_f32 v29, v29
    buffer_load_dwordx4 v[212:215], v15, s[52:55], s88 offen offset:1024 sc1
    buffer_load_dwordx4 v[216:219], v15, s[52:55], s88 offen offset:2048 sc1
    v_exp_f32 v30, v30
    v_exp_f32 v31, v31
    s_setprio 0
    v_exp_f32 v32, v32
    v_exp_f32 v33, v33
    v_smfmac_f32_32x32x32_bf16 v[48:63], v[92:95], v[24:31], v12
    s_mov_b64 exec, s[14:15]
    ds_read_b128 v[88:91], v14 offset:33792
    ds_read_b128 v[92:95], v14 offset:34048
    s_mov_b64 exec, -1
    v_exp_f32 v34, v34
    v_exp_f32 v35, v35
    v_exp_f32 v36, v36
    s_waitcnt lgkmcnt(2)
    v_mfma_f32_32x32x16_bf16 v[16:31], v[80:83], v[108:111], v[64:79]
    ds_read_b128 v[80:83], v14 offset:36864
    s_setprio 2
    v_exp_f32 v37, v37
    v_exp_f32 v38, v38
    v_exp_f32 v39, v39
    v_exp_f32 v40, v40
    v_exp_f32 v41, v41
    v_exp_f32 v42, v42
    v_smfmac_f32_32x32x32_bf16 v[48:63], v[96:99], v[32:39], v12
    v_exp_f32 v43, v43
    v_exp_f32 v44, v44
    v_exp_f32 v45, v45
    buffer_load_dwordx4 v[220:223], v15, s[52:55], s88 offen offset:3072 sc1
    s_add_u32 s88, s88, 61440
    v_exp_f32 v46, v46
    v_exp_f32 v47, v47
    s_setprio 0
    v_exp_f32 v16, v16
    v_exp_f32 v17, v17
    v_smfmac_f32_32x32x32_bf16 v[48:63], v[100:103], v[40:47], v12
    s_mov_b64 exec, s[14:15]
    ds_read_b128 v[96:99], v14 offset:37888
    ds_read_b128 v[100:103], v14 offset:38144
    s_mov_b64 exec, -1
    v_exp_f32 v18, v18
    v_exp_f32 v19, v19
    v_exp_f32 v20, v20
    s_waitcnt lgkmcnt(2)
    v_mfma_f32_32x32x16_bf16 v[32:47], v[80:83], v[108:111], v[64:79]
    ds_read_b128 v[80:83], v14 offset:40960
    s_setprio 2
    v_exp_f32 v21, v21
    v_exp_f32 v22, v22
    v_exp_f32 v23, v23
    v_exp_f32 v24, v24
    v_exp_f32 v25, v25
    v_exp_f32 v26, v26
    v_smfmac_f32_32x32x32_bf16 v[48:63], v[88:91], v[16:23], v12
    v_exp_f32 v27, v27
    v_exp_f32 v28, v28
    v_exp_f32 v29, v29
    buffer_load_dwordx4 v[224:227], v15, s[52:55], s88 offen offset:0 sc1
    buffer_load_dwordx4 v[228:231], v15, s[52:55], s88 offen offset:1024 sc1
    v_exp_f32 v30, v30
    v_exp_f32 v31, v31
    s_setprio 0
    v_exp_f32 v32, v32
    v_exp_f32 v33, v33
    v_smfmac_f32_32x32x32_bf16 v[48:63], v[92:95], v[24:31], v12
    s_mov_b64 exec, s[14:15]
    ds_read_b128 v[88:91], v14 offset:41984
    ds_read_b128 v[92:95], v14 offset:42240
    s_mov_b64 exec, -1
    v_exp_f32 v34, v34
    v_exp_f32 v35, v35
    v_exp_f32 v36, v36
    s_waitcnt lgkmcnt(2)
    v_mfma_f32_32x32x16_bf16 v[16:31], v[80:83], v[108:111], v[64:79]
    ds_read_b128 v[80:83], v14 offset:45056
    s_setprio 2
    v_exp_f32 v37, v37
    v_exp_f32 v38, v38
    v_exp_f32 v39, v39
    v_exp_f32 v40, v40
    v_exp_f32 v41, v41
    v_exp_f32 v42, v42
    v_smfmac_f32_32x32x32_bf16 v[48:63], v[96:99], v[32:39], v12
    v_exp_f32 v43, v43
    v_exp_f32 v44, v44
    v_exp_f32 v45, v45
    buffer_load_dwordx4 v[232:235], v15, s[52:55], s88 offen offset:2048 sc1
    v_exp_f32 v46, v46
    v_exp_f32 v47, v47
    s_setprio 0
    v_exp_f32 v16, v16
    v_exp_f32 v17, v17
    v_smfmac_f32_32x32x32_bf16 v[48:63], v[100:103], v[40:47], v12
    s_mov_b64 exec, s[14:15]
    ds_read_b128 v[96:99], v14 offset:46080
    ds_read_b128 v[100:103], v14 offset:46336
    s_mov_b64 exec, -1
    v_exp_f32 v18, v18
    v_exp_f32 v19, v19
    v_exp_f32 v20, v20
    s_waitcnt lgkmcnt(2)
    v_mfma_f32_32x32x16_bf16 v[32:47], v[80:83], v[108:111], v[64:79]
    ds_read_b128 v[80:83], v14 offset:49152
    s_setprio 2
    v_exp_f32 v21, v21
    v_exp_f32 v22, v22
    v_exp_f32 v23, v23
    v_exp_f32 v24, v24
    v_exp_f32 v25, v25
    v_exp_f32 v26, v26
    v_smfmac_f32_32x32x32_bf16 v[48:63], v[88:91], v[16:23], v12
    v_exp_f32 v27, v27
    v_exp_f32 v28, v28
    v_exp_f32 v29, v29
    buffer_load_dwordx4 v[236:239], v15, s[52:55], s88 offen offset:3072 sc1
    s_add_u32 s88, s88, 4096
    buffer_load_dwordx4 v[240:243], v15, s[52:55], s88 offen offset:0 sc1
    v_exp_f32 v30, v30
    v_exp_f32 v31, v31
    v_mov_b32 v11, 4884480
    buffer_load_dword v11, v11, s[52:55], 0 offen sc1
    s_setprio 0
    v_exp_f32 v32, v32
    v_exp_f32 v33, v33
    v_smfmac_f32_32x32x32_bf16 v[48:63], v[92:95], v[24:31], v12
    s_mov_b64 exec, s[14:15]
    ds_read_b128 v[88:91], v14 offset:50176
    ds_read_b128 v[92:95], v14 offset:50432
    s_mov_b64 exec, -1
    v_exp_f32 v34, v34
    v_exp_f32 v35, v35
    v_exp_f32 v36, v36
    s_waitcnt lgkmcnt(2)
    v_mfma_f32_32x32x16_bf16 v[16:31], v[80:83], v[108:111], v[64:79]
    ds_read_b128 v[80:83], v14 offset:53248
    s_setprio 2
    v_exp_f32 v37, v37
    v_exp_f32 v38, v38
    v_exp_f32 v39, v39
    v_exp_f32 v40, v40
    v_exp_f32 v41, v41
    v_exp_f32 v42, v42
    v_smfmac_f32_32x32x32_bf16 v[48:63], v[96:99], v[32:39], v12
    v_exp_f32 v43, v43
    v_exp_f32 v44, v44
    v_exp_f32 v45, v45
    buffer_load_dwordx4 v[244:247], v15, s[52:55], s88 offen offset:1024 sc1
    v_exp_f32 v46, v46
    v_exp_f32 v47, v47
    s_setprio 0
    v_exp_f32 v16, v16
    v_exp_f32 v17, v17
    v_smfmac_f32_32x32x32_bf16 v[48:63], v[100:103], v[40:47], v12
    s_mov_b64 exec, s[14:15]
    ds_read_b128 v[96:99], v14 offset:54272
    ds_read_b128 v[100:103], v14 offset:54528
    s_mov_b64 exec, -1
    v_exp_f32 v18, v18
    v_exp_f32 v19, v19
    v_exp_f32 v20, v20
    s_waitcnt lgkmcnt(2)
    v_mfma_f32_32x32x16_bf16 v[32:47], v[80:83], v[108:111], v[64:79]
    ds_read_b128 v[80:83], v14 offset:57344
    s_setprio 2
    v_exp_f32 v21, v21
    v_exp_f32 v22, v22
    v_exp_f32 v23, v23
    v_exp_f32 v24, v24
    v_exp_f32 v25, v25
    v_exp_f32 v26, v26
    v_smfmac_f32_32x32x32_bf16 v[48:63], v[88:91], v[16:23], v12
    v_exp_f32 v27, v27
    v_exp_f32 v28, v28
    v_exp_f32 v29, v29
    buffer_load_dwordx4 v[248:251], v15, s[52:55], s88 offen offset:2048 sc1
    buffer_load_dwordx4 v[252:255], v15, s[52:55], s88 offen offset:3072 sc1
    s_add_u32 s88, s88, 61440
    v_exp_f32 v30, v30
    v_exp_f32 v31, v31
    s_setprio 0
    v_exp_f32 v32, v32
    v_exp_f32 v33, v33
    v_smfmac_f32_32x32x32_bf16 v[48:63], v[92:95], v[24:31], v12
    s_mov_b64 exec, s[14:15]
    ds_read_b128 v[88:91], v14 offset:58368
    ds_read_b128 v[92:95], v14 offset:58624
    s_mov_b64 exec, -1
    v_exp_f32 v34, v34
    v_exp_f32 v35, v35
    v_exp_f32 v36, v36
    s_waitcnt lgkmcnt(2)
    v_mfma_f32_32x32x16_bf16 v[16:31], v[80:83], v[108:111], v[64:79]
    ds_read_b128 v[80:83], v14 offset:61440
    s_setprio 2
    v_exp_f32 v37, v37
    v_exp_f32 v38, v38
    v_exp_f32 v39, v39
    v_exp_f32 v40, v40
    v_exp_f32 v41, v41
    v_exp_f32 v42, v42
    v_smfmac_f32_32x32x32_bf16 v[48:63], v[96:99], v[32:39], v12
    v_exp_f32 v43, v43
    v_exp_f32 v44, v44
    v_exp_f32 v45, v45
    v_exp_f32 v46, v46
    v_exp_f32 v47, v47
    s_setprio 0
    v_exp_f32 v16, v16
    v_exp_f32 v17, v17
    v_smfmac_f32_32x32x32_bf16 v[48:63], v[100:103], v[40:47], v12
    s_mov_b64 exec, s[14:15]
    ds_read_b128 v[96:99], v14 offset:62464
    ds_read_b128 v[100:103], v14 offset:62720
    s_mov_b64 exec, -1
    v_exp_f32 v18, v18
    v_exp_f32 v19, v19
    v_exp_f32 v20, v20
    s_waitcnt lgkmcnt(2)
    v_mfma_f32_32x32x16_bf16 v[32:47], v[80:83], v[108:111], v[64:79]
    s_setprio 2
    v_exp_f32 v21, v21
    v_exp_f32 v22, v22
    v_exp_f32 v23, v23
    v_exp_f32 v24, v24
    v_exp_f32 v25, v25
    v_exp_f32 v26, v26
    v_smfmac_f32_32x32x32_bf16 v[48:63], v[88:91], v[16:23], v12
    v_exp_f32 v27, v27
    v_exp_f32 v28, v28
    v_exp_f32 v29, v29
    v_exp_f32 v30, v30
    v_exp_f32 v31, v31
    s_setprio 0
    v_exp_f32 v32, v32
    v_exp_f32 v33, v33
    v_smfmac_f32_32x32x32_bf16 v[48:63], v[92:95], v[24:31], v12
    v_exp_f32 v34, v34
    v_exp_f32 v35, v35
    v_exp_f32 v36, v36
    s_waitcnt lgkmcnt(0)
    s_setprio 2
    v_exp_f32 v37, v37
    v_exp_f32 v38, v38
    v_exp_f32 v39, v39
    v_exp_f32 v40, v40
    v_exp_f32 v41, v41
    v_exp_f32 v42, v42
    v_smfmac_f32_32x32x32_bf16 v[48:63], v[96:99], v[32:39], v12
    v_exp_f32 v43, v43
    v_exp_f32 v44, v44
    v_exp_f32 v45, v45
    v_exp_f32 v46, v46
    v_exp_f32 v47, v47
    s_mul_i32 s9, s5, 2304
    s_add_u32 s9, s9, 131072
    v_add_u32 v2, s9, v15
    v_lshl_add_u32 v3, v1, 2, s9
    v_smfmac_f32_32x32x32_bf16 v[48:63], v[100:103], v[40:47], v12
    s_setprio 0
    s_nop 10
    ds_write_b128 v2, v[48:51]
    ds_write_b128 v2, v[52:55] offset:1024
    ds_write_b32 v3, v56 offset:2048
    s_and_b32 s9, s5, 3
    s_mul_i32 s10, s9, 2304
    s_add_u32 s10, s10, 131072
    s_lshl_b32 s11, s90, 10
    s_add_u32 s11, s11, s10
    v_add_u32 v2, s11, v15
    v_lshl_add_u32 v3, v1, 2, s10
    s_waitcnt lgkmcnt(0)
    s_barrier
    ds_read_b32 v8, v3 offset:2048
    ds_read_b32 v9, v3 offset:11264
    ds_read_b128 v[4:7], v2
    ds_read_b128 v[84:87], v2 offset:9216
    v_and_b32 v2, 31, v1
    v_lshlrev_b32 v2, 5, v2
    v_lshrrev_b32 v3, 5, v1
    v_lshl_add_u32 v2, v3, 4, v2
    s_lshl_b32 s9, s9, 10
    s_lshl_b32 s10, s90, 3
    s_add_u32 s9, s9, s10
    s_add_u32 s9, s9, 153600
    v_add_u32 v2, s9, v2
    s_waitcnt lgkmcnt(0)
    v_add_f32 v8, v8, v9
    v_rcp_f32 v8, v8
    v_pk_add_f32 v[4:5], v[4:5], v[84:85]
    v_pk_add_f32 v[6:7], v[6:7], v[86:87]
    v_pk_mul_f32 v[4:5], v[4:5], v[8:9] op_sel_hi:[1,0]
    v_pk_mul_f32 v[6:7], v[6:7], v[8:9] op_sel_hi:[1,0]
    v_cvt_pk_bf16_f32 v4, v4, v5
    v_cvt_pk_bf16_f32 v5, v6, v7
    ds_write_b64 v2, v[4:5]
    v_add_u32 v2, 153600, v15
    s_waitcnt lgkmcnt(0)
    s_barrier
    ds_read_b128 v[84:87], v2 offset:0
    ds_read_b128 v[4:7], v2 offset:1024
    ds_read_b128 v[16:19], v2 offset:2048
    ds_read_b128 v[20:23], v2 offset:3072
    v_lshrrev_b32 v2, 4, v1
    v_lshlrev_b32 v2, 12, v2
    v_and_b32 v3, 15, v1
    v_lshl_add_u32 v2, v3, 3, v2
    s_lshl_b32 s9, s4, 14
    s_lshl_b32 s10, s5, 7
    s_add_u32 s9, s9, s10
    s_waitcnt vmcnt(0)
    v_readfirstlane_b32 s10, v11
    s_waitcnt lgkmcnt(3)
    v_smfmac_f32_16x16x64_bf16 v[112:115], v[84:87], v[128:135], v13
    v_smfmac_f32_16x16x64_bf16 v[116:119], v[84:87], v[136:143], v13
    v_smfmac_f32_16x16x64_bf16 v[120:123], v[84:87], v[144:151], v13
    v_smfmac_f32_16x16x64_bf16 v[124:127], v[84:87], v[152:159], v13
    s_waitcnt lgkmcnt(2)
    v_smfmac_f32_16x16x64_bf16 v[112:115], v[4:7], v[160:167], v13
    v_smfmac_f32_16x16x64_bf16 v[116:119], v[4:7], v[168:175], v13
    v_smfmac_f32_16x16x64_bf16 v[120:123], v[4:7], v[176:183], v13
    v_smfmac_f32_16x16x64_bf16 v[124:127], v[4:7], v[184:191], v13
    s_waitcnt lgkmcnt(1)
    v_smfmac_f32_16x16x64_bf16 v[112:115], v[16:19], v[192:199], v13
    v_smfmac_f32_16x16x64_bf16 v[116:119], v[16:19], v[200:207], v13
    v_smfmac_f32_16x16x64_bf16 v[120:123], v[16:19], v[208:215], v13
    v_smfmac_f32_16x16x64_bf16 v[124:127], v[16:19], v[216:223], v13
    s_waitcnt lgkmcnt(0)
    v_smfmac_f32_16x16x64_bf16 v[112:115], v[20:23], v[224:231], v13
    v_smfmac_f32_16x16x64_bf16 v[116:119], v[20:23], v[232:239], v13
    v_smfmac_f32_16x16x64_bf16 v[120:123], v[20:23], v[240:247], v13
    v_smfmac_f32_16x16x64_bf16 v[124:127], v[20:23], v[248:255], v13
    s_nop 4
    v_add_f32 v112, v112, v113
    v_add_f32 v114, v114, v115
    v_add_f32 v116, v116, v117
    v_add_f32 v118, v118, v119
    v_add_f32 v120, v120, v121
    v_add_f32 v122, v122, v123
    v_add_f32 v124, v124, v125
    v_add_f32 v126, v126, v127
    v_cvt_pk_bf16_f32 v4, v112, v116
    v_cvt_pk_bf16_f32 v5, v120, v124
    v_cvt_pk_bf16_f32 v6, v114, v118
    v_cvt_pk_bf16_f32 v7, v122, v126
    buffer_store_dwordx2 v[4:5], v2, s[56:59], s9 offen offset:1024
    buffer_store_dwordx2 v[6:7], v2, s[56:59], s9 offen offset:3072
    s_or_b32 s9, s5, s50
    s_cmp_lg_u32 s9, 0
    s_cbranch_scc1 L_noep1
    s_cmp_eq_u32 s10, s51
    s_cbranch_scc1 L_noep1
    v_mov_b32 v2, 0
    v_mov_b32 v3, s51
    s_mov_b32 s9, 4884480
    s_mov_b64 exec, 1
    buffer_store_dword v3, v2, s[52:55], s9 offen sc1
    s_mov_b64 exec, -1
L_noep1:
L_end:
    s_endpgm
L_slow:
    s_bitcmp1_b32 s101, 0
    s_cbranch_scc1 L_fallback
    s_waitcnt lgkmcnt(0)
    s_mov_b32 s9, 4718592
    s_mov_b32 s13, 64
    v_mov_b32 v2, 0xff800000
    v_mov_b32 v11, 0xff800000
L_mxl_43:
    buffer_load_dwordx4 v[4:7], v15, s[52:55], s9 offen sc1
    s_add_u32 s9, s9, 2048
    s_waitcnt vmcnt(0)
    v_mfma_f32_32x32x16_bf16 v[16:31], v[4:7], v[104:107], 0
    v_mfma_f32_32x32x16_bf16 v[32:47], v[4:7], v[108:111], 0
    s_nop 15
    v_max3_f32 v2, v2, v16, v17
    v_max3_f32 v2, v2, v18, v19
    v_max3_f32 v2, v2, v20, v21
    v_max3_f32 v2, v2, v22, v23
    v_max3_f32 v2, v2, v24, v25
    v_max3_f32 v2, v2, v26, v27
    v_max3_f32 v2, v2, v28, v29
    v_max3_f32 v2, v2, v30, v31
    v_max3_f32 v11, v11, v32, v33
    v_max3_f32 v11, v11, v34, v35
    v_max3_f32 v11, v11, v36, v37
    v_max3_f32 v11, v11, v38, v39
    v_max3_f32 v11, v11, v40, v41
    v_max3_f32 v11, v11, v42, v43
    v_max3_f32 v11, v11, v44, v45
    v_max3_f32 v11, v11, v46, v47
    s_sub_u32 s13, s13, 1
    s_cmp_lg_u32 s13, 0
    s_cbranch_scc1 L_mxl_43
    v_mov_b32 v3, v2
    v_mov_b32 v4, v11
    s_nop 1
    v_permlane32_swap_b32 v2, v3
    v_permlane32_swap_b32 v11, v4
    s_nop 1
    v_max_f32 v2, v2, v3
    v_max_f32 v11, v11, v4
    v_sub_f32 v2, 0, v2
    v_sub_f32 v11, 0, v11
    v_mov_b32 v3, v2
    v_mov_b64 v[64:65], v[2:3]
    v_mov_b64 v[66:67], v[2:3]
    v_mov_b64 v[68:69], v[2:3]
    v_mov_b64 v[70:71], v[2:3]
    v_mov_b64 v[72:73], v[2:3]
    v_mov_b64 v[74:75], v[2:3]
    v_mov_b64 v[76:77], v[2:3]
    v_mov_b64 v[78:79], v[2:3]
    s_nop 1
    s_branch L_slow_done
L_scatter:
    v_lshlrev_b32 v2, 14, v1
    s_and_b32 s9, s5, 3
    s_lshl_b32 s9, s9, 20
    s_lshl_b32 s10, s4, 2
    s_add_u32 s9, s9, s10
    s_lshl_b32 s10, s90, 1
    s_add_u32 s9, s9, s10
    buffer_store_short v144, v2, s[56:59], s9 offen
    buffer_store_short_d16_hi v144, v2, s[56:59], s9 offen offset:2048
    s_add_u32 s9, s9, 4096
    buffer_store_short v145, v2, s[56:59], s9 offen
    buffer_store_short_d16_hi v145, v2, s[56:59], s9 offen offset:2048
    s_add_u32 s9, s9, 4096
    buffer_store_short v146, v2, s[56:59], s9 offen
    buffer_store_short_d16_hi v146, v2, s[56:59], s9 offen offset:2048
    s_add_u32 s9, s9, 4096
    buffer_store_short v147, v2, s[56:59], s9 offen
    buffer_store_short_d16_hi v147, v2, s[56:59], s9 offen offset:2048
    s_add_u32 s9, s9, 4096
    s_waitcnt vmcnt(0)
    s_branch L_scatter_done
L_cspin:
    s_mov_b32 s13, 0
L_cspin1:
    s_sleep 4
    buffer_load_dword v8, v255, s[52:55], s93 offen sc1
    s_add_u32 s13, s13, 1
    s_waitcnt vmcnt(0)
    v_cmp_ne_u32 s[80:81], s51, v8
    s_cmp_eq_u64 s[80:81], 0
    s_cbranch_scc1 L_cok
    s_cmp_lt_u32 s13, 4194304
    s_cbranch_scc1 L_cspin1
    s_branch L_cok
L_sbs_35:
    v_mov_b32 v9, 157696
    ds_read_b32 v9, v9 offset:0
    s_waitcnt lgkmcnt(0)
    v_readfirstlane_b32 s12, v9
    s_cmp_lg_u32 s12, 8
    s_cbranch_scc1 L_sbs_35
    s_branch L_sbo_36
L_sbs_37:
    v_mov_b32 v9, 157696
    ds_read_b32 v9, v9 offset:4
    s_waitcnt lgkmcnt(0)
    v_readfirstlane_b32 s12, v9
    s_cmp_lg_u32 s12, 8
    s_cbranch_scc1 L_sbs_37
    s_branch L_sbo_38
L_sbs_39:
    v_mov_b32 v9, 157696
    ds_read_b32 v9, v9 offset:8
    s_waitcnt lgkmcnt(0)
    v_readfirstlane_b32 s12, v9
    s_cmp_lg_u32 s12, 8
    s_cbranch_scc1 L_sbs_39
    s_branch L_sbo_40
L_sbs_41:
    v_mov_b32 v9, 157696
    ds_read_b32 v9, v9 offset:12
    s_waitcnt lgkmcnt(0)
    v_readfirstlane_b32 s12, v9
    s_cmp_lg_u32 s12, 8
    s_cbranch_scc1 L_sbs_41
    s_branch L_sbo_42
L_upend:
    s_mov_b32 s13, 0
    s_cmp_lg_u32 s50, 0
    s_cbranch_scc1 L_aok_44
L_aspin_45:
    buffer_load_dwordx2 v[82:83], v43, s[52:55], s88 offen sc1
    s_add_u32 s13, s13, 1
    s_waitcnt vmcnt(0)
    v_xor_b32 v82, s51, v82
    v_xor_b32 v83, s51, v83
    v_or_b32 v82, v82, v83
    v_cmp_ne_u32 vcc, 0, v82
    s_cbranch_vccz L_aok_44
    s_mov_b64 exec, vcc
    s_sleep 16
    s_cmp_lt_u32 s13, 20000
    s_cbranch_scc1 L_aspin_45
    s_mov_b32 s91, 1
L_aok_44:
    s_mov_b64 exec, -1
    s_lshr_b32 s9, s4, 1
    s_lshl_b32 s9, s9, 14
    s_and_b32 s10, s4, 1
    s_lshl_b32 s10, s10, 5
    s_add_u32 s9, s9, s10
    s_add_u32 s9, s9, 2097152
    s_nop 0
    buffer_load_dwordx4 v[144:147], v37, s[52:55], s9 offen offset:0 sc1
    buffer_load_dwordx4 v[148:151], v37, s[52:55], s9 offen offset:2048 sc1
    s_add_u32 s9, s9, 4096
    buffer_load_dwordx4 v[152:155], v37, s[52:55], s9 offen offset:0 sc1
    buffer_load_dwordx4 v[156:159], v37, s[52:55], s9 offen offset:2048 sc1
    s_add_u32 s9, s9, 4096
    buffer_load_dwordx4 v[160:163], v37, s[52:55], s9 offen offset:0 sc1
    buffer_load_dwordx4 v[164:167], v37, s[52:55], s9 offen offset:2048 sc1
    s_add_u32 s9, s9, 4096
    buffer_load_dwordx4 v[168:171], v37, s[52:55], s9 offen offset:0 sc1
    buffer_load_dwordx4 v[172:175], v37, s[52:55], s9 offen offset:2048 sc1
    s_add_u32 s9, s9, 4096
    s_waitcnt vmcnt(0)
    s_branch L_uok
L_fallback:
    s_and_b32 s50, s101, 12
    s_or_b32 s50, s50, 16
    s_mov_b32 s91, 0
    s_mov_b32 s3, 0
    v_and_b32 v2, 255, v0
    v_lshlrev_b32 v2, 1, v2
    s_lshl_b32 s9, s4, 9
    v_add_u32 v9, s9, v2
    s_waitcnt vmcnt(0) lgkmcnt(0)
    s_barrier
    s_branch L_phase1
L_code_end:
.section .rodata,"a"
.p2align 6
.amdhsa_kernel concat_heads__ssm_conv_s4__grouped_kv_mqa__prompt_kernel
  .amdhsa_next_free_vgpr 256
  .amdhsa_next_free_sgpr 102
  .amdhsa_accum_offset 256
  .amdhsa_group_segment_fixed_size 0
  .amdhsa_kernarg_size 136
  .amdhsa_user_sgpr_count 2
  .amdhsa_user_sgpr_kernarg_segment_ptr 1
  .amdhsa_system_sgpr_workgroup_id_x 1
.end_amdhsa_kernel
```
